```python
import torch

def _softmax(x, axis=-1):
    return torch.softmax(x, dim=axis)
def _gelu(x):
    return torch.nn.functional.gelu(x, approximate="tanh")
def _silu(x):
    return torch.nn.functional.silu(x)
def _sigmoid(x):
    return torch.sigmoid(x)
def _layernorm(x, axis=-1, eps=1e-5):
    m = x.mean(dim=axis, keepdim=True)
    v = x.var(dim=axis, keepdim=True, unbiased=False)
    return (x - m) / torch.sqrt(v + eps)
def _scatter_add(tgt, idx, src, axis=0):
    return tgt.clone().index_add_(axis, idx, src)
def _segment_sum(src, seg, n):
    out = torch.zeros((n,) + src.shape[1:], dtype=src.dtype)
    return out.index_add_(0, seg, src)
def _pad(x, pw):
    flat = tuple(v for pair in reversed(pw) for v in pair)
    return torch.nn.functional.pad(x, flat)

kernel_name = 'concat_heads__mha_block_cached__gqa_block_cached__near_ridge'

def setup_inputs():

    _w = (lambda a: (lambda t: t.to(torch.bfloat16) if t.is_floating_point() else t)(torch.as_tensor(a)))
    def _A_setup():
        B, Sq, D = 8, 128, 1024
        H, Sk, Dh = 32, 512, 128
        return {
            "x": _w((lambda *s: torch.randn(*s, dtype=torch.bfloat16) * 0.8)(B, Sq, D)),
            "k_cache": _w((lambda *s: torch.randn(*s, dtype=torch.bfloat16) * 0.8)(B, H, Sk, Dh)),
            "v_cache": _w((lambda *s: torch.randn(*s, dtype=torch.bfloat16) * 0.05)(B, H, Sk, Dh)),
            "wq": _w((lambda *s: torch.randn(*s, dtype=torch.bfloat16) * 0.8)(D, H * Dh) * (D ** -0.5)),
            "wo": _w((lambda *s: torch.randn(*s, dtype=torch.bfloat16) * 0.05)(H * Dh, D) * ((H * Dh) ** -0.5)),
        }
    _A_in = _A_setup()

    def _B_setup():
        B, Sq, D = 8, 128, 1024
        Hq, Hkv, Sk, Dh = 32, 32, 512, 128
        assert Hq % Hkv == 0, (Hq, Hkv)
        return {
            "x": _w((lambda *s: torch.randn(*s, dtype=torch.bfloat16) * 0.8)(B, Sq, D)),
            "k_cache": _w((lambda *s: torch.randn(*s, dtype=torch.bfloat16) * 0.8)(B, Hkv, Sk, Dh)),
            "v_cache": _w((lambda *s: torch.randn(*s, dtype=torch.bfloat16) * 0.05)(B, Hkv, Sk, Dh)),
            "wq": _w((lambda *s: torch.randn(*s, dtype=torch.bfloat16) * 0.8)(D, Hq * Dh) * (D ** -0.5)),
            "wo": _w((lambda *s: torch.randn(*s, dtype=torch.bfloat16) * 0.05)(Hq * Dh, D) * ((Hq * Dh) ** -0.5)),
        }
    _B_in = _B_setup()

    return {
        "A_x": _A_in["x"],
        "A_k_cache": _A_in["k_cache"],
        "A_v_cache": _A_in["v_cache"],
        "A_wq": _A_in["wq"],
        "A_wo": _A_in["wo"],
        "B_x": _B_in["x"],
        "B_k_cache": _B_in["k_cache"],
        "B_v_cache": _B_in["v_cache"],
        "B_wq": _B_in["wq"],
        "B_wo": _B_in["wo"],
    }

def reference(A_x, A_k_cache, A_v_cache, A_wq, A_wo, B_x, B_k_cache, B_v_cache, B_wq, B_wo):
    def _A_ref(x, k_cache, v_cache, wq, wo):
        B, Sq, D = x.shape
        H, Dh = 32, 128
        q = (lambda x, *d: x.permute(*d))((x @ wq).reshape(B, Sq, H, Dh), 0, 2, 1, 3)
        scores = torch.einsum("bhqd,bhkd->bhqk", q, k_cache) * (Dh ** -0.5)
        p = _softmax(scores, axis=-1)
        o = torch.einsum("bhqk,bhkd->bhqd", p, v_cache)
        return (lambda x, *d: x.permute(*d))(o, 0, 2, 1, 3).reshape(B, Sq, H * Dh) @ wo

    def _B_ref(x, k_cache, v_cache, wq, wo):
        B, Sq, D = x.shape
        Hq, Dh = 32, 128
        Hkv = k_cache.shape[1]
        rep = Hq // Hkv
        q = (lambda x, *d: x.permute(*d))((x @ wq).reshape(B, Sq, Hq, Dh), 0, 2, 1, 3)
        k = (lambda x, n, axis: torch.repeat_interleave(x, n, dim=axis))(k_cache, rep, axis=1)
        v = (lambda x, n, axis: torch.repeat_interleave(x, n, dim=axis))(v_cache, rep, axis=1)
        scores = torch.einsum("bhqd,bhkd->bhqk", q, k) * (Dh ** -0.5)
        p = _softmax(scores, axis=-1)
        o = torch.einsum("bhqk,bhkd->bhqd", p, v)
        return (lambda x, *d: x.permute(*d))(o, 0, 2, 1, 3).reshape(B, Sq, Hq * Dh) @ wo

    a = _A_ref(A_x, A_k_cache, A_v_cache, A_wq, A_wo)
    b = _B_ref(B_x, B_k_cache, B_v_cache, B_wq, B_wo)
    return torch.concatenate([a, b], axis=-1)
```

```asm
; @launch grid=(256,1,1) block=(512,1,1) lds=163840
.amdgcn_target "amdgcn-amd-amdhsa--gfx950"
.text
.globl concat_heads__mha_block_cached__gqa_block_cached__near_ridge_kernel
.p2align 8
.type concat_heads__mha_block_cached__gqa_block_cached__near_ridge_kernel,@function
concat_heads__mha_block_cached__gqa_block_cached__near_ridge_kernel:
    s_cmp_ge_u32 s2, 256
    s_cbranch_scc1 L_end
    s_bfe_u32 s42, s2, 0x10002
    s_mul_i32 s3, s42, 40
    s_add_u32 s4, s0, s3
    s_addc_u32 s5, s1, 0
    s_load_dwordx2 s[8:9], s[4:5], 0
    s_load_dwordx2 s[20:21], s[4:5], 24
    v_lshrrev_b32 v1, 6, v0
    v_and_b32 v0, 63, v0
    v_readfirstlane_b32 s46, v1
    s_and_b32 s43, s2, 3
    s_lshr_b32 s44, s2, 5
    s_bfe_u32 s45, s2, 0x20003
    s_lshl_b32 s47, s43, 2
    s_add_u32 s47, s47, s45
    s_lshl_b32 s47, s47, 1
    s_add_u32 s48, s45, s44
    s_cmp_lt_u32 s46, 4
    s_cbranch_scc1 L_compute
    s_sub_u32 s46, s46, 4
    s_mov_b32 s10, 2097152
    s_mov_b32 s11, 0x00020000
    s_mov_b32 s22, 8388608
    s_mov_b32 s23, 0x00020000
    v_lshrrev_b32 v1, 3, v0
    v_and_b32 v2, 7, v0
    v_lshrrev_b32 v3, 4, v0
    v_xor_b32 v2, v2, v3
    v_lshlrev_b32 v2, 4, v2
    v_lshl_add_u32 v4, v1, 11, v2
    v_xor_b32 v2, 64, v4
    v_add_u32 v5, 15360, v2
    v_add_u32 v6, 30720, v4
    v_add_u32 v7, 46080, v2
    v_and_b32 v1, 15, v0
    v_lshlrev_b32 v30, 2, v3
    v_xor_b32 v2, v1, v30
    v_lshlrev_b32 v30, 4, v2
    v_lshl_add_u32 v8, v3, 13, v30
    v_xor_b32 v30, 32, v8
    v_add_u32 v9, 31744, v8
    v_add_u32 v10, 63488, v30
    v_add_u32 v11, 95232, v30
    s_lshl_b32 s67, s44, 2
    s_add_u32 s67, s67, s46
    s_lshl_b32 s67, s67, 16
    s_lshl_b32 s68, s46, 9
    s_add_u32 s68, s68, s47
    s_lshl_b32 s68, s68, 8
    s_lshl_b32 s66, s46, 12
    s_waitcnt lgkmcnt(0)
    s_add_u32 s61, s67, 0
    s_add_u32 s62, s68, 0
    s_add_u32 s63, s62, 256
    s_add_u32 m0, s66, 16384
    s_nop 0
    buffer_load_dwordx4 v4, s[8:11], s61 offen offset:0  lds
    buffer_load_dwordx4 v5, s[8:11], s61 offen offset:1024  lds
    buffer_load_dwordx4 v6, s[8:11], s61 offen offset:2048  lds
    buffer_load_dwordx4 v7, s[8:11], s61 offen offset:3072  lds
    s_add_u32 m0, s66, 32768
    s_nop 0
    buffer_load_dwordx4 v8, s[20:23], s62 offen offset:0  lds
    buffer_load_dwordx4 v9, s[20:23], s62 offen offset:1024  lds
    buffer_load_dwordx4 v10, s[20:23], s62 offen offset:2048  lds
    buffer_load_dwordx4 v11, s[20:23], s62 offen offset:3072  lds
    s_add_u32 m0, s66, 49152
    s_nop 0
    buffer_load_dwordx4 v8, s[20:23], s63 offen offset:0  lds
    buffer_load_dwordx4 v9, s[20:23], s63 offen offset:1024  lds
    buffer_load_dwordx4 v10, s[20:23], s63 offen offset:2048  lds
    buffer_load_dwordx4 v11, s[20:23], s63 offen offset:3072  lds
    s_load_dwordx2 s[12:13], s[4:5], 8
    s_load_dwordx2 s[16:17], s[4:5], 16
    s_load_dwordx2 s[24:25], s[4:5], 32
    s_load_dwordx2 s[28:29], s[0:1], 80
    s_load_dwordx2 s[36:37], s[0:1], 88
    s_load_dwordx2 s[32:33], s[0:1], 96
    s_and_b32 s40, s2, 7
    s_lshr_b32 s41, s2, 3
    s_mov_b32 s14, 33554432
    s_mov_b32 s15, 0x00020000
    s_mov_b32 s18, 33554432
    s_mov_b32 s19, 0x00020000
    s_mov_b32 s26, 8388608
    s_mov_b32 s27, 0x00020000
    s_mov_b32 s30, 4194304
    s_mov_b32 s31, 0x00020000
    s_mov_b32 s34, 67108864
    s_mov_b32 s35, 0x00020000
    s_mov_b32 s38, 256
    s_mov_b32 s39, 0x00020000
    s_and_b32 s71, s48, 3
    s_lshl_b32 s3, s42, 3
    s_add_u32 s64, s3, s44
    s_lshl_b32 s59, s64, 4
    s_lshl_b32 s3, s43, 2
    s_add_u32 s3, s3, s71
    s_add_u32 s60, s3, s59
    s_lshl_b32 s70, s64, 20
    s_lshl_b32 s65, s46, 15
    v_bfe_u32 v30, v0, 2, 2
    v_lshlrev_b32 v30, 8, v30
    v_lshl_add_u32 v30, v3, 6, v30
    v_and_b32 v31, 3, v0
    v_lshl_add_u32 v30, v31, 4, v30
    v_add_u32 v16, s66, v30
    v_xor_b32 v17, 32, v16
    s_lshl_b32 s3, s46, 1
    s_sub_u32 s3, 8, s3
    s_and_b32 s3, s3, 3
    s_lshl_b32 s3, s3, 4
    v_xor_b32 v12, s3, v16
    s_lshl_b32 s3, s46, 1
    s_sub_u32 s3, 7, s3
    s_and_b32 s3, s3, 3
    s_lshl_b32 s3, s3, 4
    v_xor_b32 v13, s3, v16
    v_xor_b32 v30, 0, v2
    v_lshlrev_b32 v30, 4, v30
    v_add_u32 v31, 0, v3
    v_lshl_add_u32 v30, v31, 11, v30
    v_add_u32 v30, s65, v30
    v_subrev_u32 v20, 0, v30
    v_xor_b32 v30, 0, v2
    v_lshlrev_b32 v30, 4, v30
    v_add_u32 v31, 4, v3
    v_lshl_add_u32 v30, v31, 11, v30
    v_add_u32 v30, s65, v30
    v_subrev_u32 v21, 1024, v30
    v_xor_b32 v30, 2, v2
    v_lshlrev_b32 v30, 4, v30
    v_add_u32 v31, 8, v3
    v_lshl_add_u32 v30, v31, 11, v30
    v_add_u32 v30, s65, v30
    v_subrev_u32 v22, 2048, v30
    v_xor_b32 v30, 2, v2
    v_lshlrev_b32 v30, 4, v30
    v_add_u32 v31, 12, v3
    v_lshl_add_u32 v30, v31, 11, v30
    v_add_u32 v30, s65, v30
    v_subrev_u32 v23, 3072, v30
    v_lshlrev_b32 v30, 4, v0
    v_add_u32 v24, s66, v30
    v_lshlrev_b32 v27, 2, v1
    v_and_b32 v26, 12, v27
    v_lshlrev_b32 v28, 10, v0
    v_mov_b32 v29, 1
    s_lshl_b32 s3, s60, 10
    s_add_u32 s74, s3, 31457280
    s_lshl_b32 s3, s44, 5
    s_add_u32 s3, s3, s47
    s_lshl_b32 s69, s3, 17
    s_lshl_b32 s3, s47, 15
    s_add_u32 s73, s70, s3
    s_mov_b32 s88, 0
    s_add_u32 s89, s69, 131072
    s_add_u32 s3, s45, 0
    s_and_b32 s3, s3, 3
    s_lshl_b32 s64, s43, 2
    s_add_u32 s3, s3, s64
    s_lshl_b32 s64, s3, 16
    s_add_u32 s80, s64, s70
    s_lshl_b32 s64, s3, 19
    s_lshl_b32 s3, s71, 9
    s_add_u32 s84, s64, s3
    s_add_u32 s3, s45, 1
    s_and_b32 s3, s3, 3
    s_lshl_b32 s64, s43, 2
    s_add_u32 s3, s3, s64
    s_lshl_b32 s64, s3, 16
    s_add_u32 s81, s64, s70
    s_lshl_b32 s64, s3, 19
    s_lshl_b32 s3, s71, 9
    s_add_u32 s85, s64, s3
    s_add_u32 s3, s45, 2
    s_and_b32 s3, s3, 3
    s_lshl_b32 s64, s43, 2
    s_add_u32 s3, s3, s64
    s_lshl_b32 s64, s3, 16
    s_add_u32 s82, s64, s70
    s_lshl_b32 s64, s3, 19
    s_lshl_b32 s3, s71, 9
    s_add_u32 s86, s64, s3
    s_add_u32 s3, s45, 3
    s_and_b32 s3, s3, 3
    s_lshl_b32 s64, s43, 2
    s_add_u32 s3, s3, s64
    s_lshl_b32 s64, s3, 16
    s_add_u32 s83, s64, s70
    s_lshl_b32 s64, s3, 19
    s_lshl_b32 s3, s71, 9
    s_add_u32 s87, s64, s3
    s_waitcnt lgkmcnt(0)
    s_lshl_b32 s3, s46, 7
    s_add_u32 s3, s3, s69
    s_add_u32 s3, s3, 60
    s_add_u32 s94, s12, s3
    s_addc_u32 s95, s13, 0
    s_add_u32 s96, s16, s3
    s_addc_u32 s97, s17, 0
    s_add_u32 s61, s67, 128
    s_add_u32 s62, s68, 524288
    s_add_u32 s63, s62, 256
    s_add_u32 m0, s66, 65536
    s_nop 0
    buffer_load_dwordx4 v4, s[8:11], s61 offen offset:0  lds
    buffer_load_dwordx4 v5, s[8:11], s61 offen offset:1024  lds
    buffer_load_dwordx4 v6, s[8:11], s61 offen offset:2048  lds
    buffer_load_dwordx4 v7, s[8:11], s61 offen offset:3072  lds
    s_add_u32 m0, s66, 81920
    s_nop 0
    buffer_load_dwordx4 v8, s[20:23], s62 offen offset:0  lds
    buffer_load_dwordx4 v9, s[20:23], s62 offen offset:1024  lds
    buffer_load_dwordx4 v10, s[20:23], s62 offen offset:2048  lds
    buffer_load_dwordx4 v11, s[20:23], s62 offen offset:3072  lds
    s_add_u32 m0, s66, 98304
    s_nop 0
    buffer_load_dwordx4 v8, s[20:23], s63 offen offset:0  lds
    buffer_load_dwordx4 v9, s[20:23], s63 offen offset:1024  lds
    buffer_load_dwordx4 v10, s[20:23], s63 offen offset:2048  lds
    buffer_load_dwordx4 v11, s[20:23], s63 offen offset:3072  lds
    s_waitcnt vmcnt(12)
    s_barrier
    s_add_u32 s61, s67, 256
    s_add_u32 s62, s68, 1048576
    s_add_u32 s63, s62, 256
    s_add_u32 m0, s66, 114688
    s_nop 0
    buffer_load_dwordx4 v4, s[8:11], s61 offen offset:0  lds
    buffer_load_dwordx4 v5, s[8:11], s61 offen offset:1024  lds
    buffer_load_dwordx4 v6, s[8:11], s61 offen offset:2048  lds
    buffer_load_dwordx4 v7, s[8:11], s61 offen offset:3072  lds
    s_add_u32 m0, s66, 131072
    s_nop 0
    buffer_load_dwordx4 v8, s[20:23], s62 offen offset:0  lds
    buffer_load_dwordx4 v9, s[20:23], s62 offen offset:1024  lds
    buffer_load_dwordx4 v10, s[20:23], s62 offen offset:2048  lds
    buffer_load_dwordx4 v11, s[20:23], s62 offen offset:3072  lds
    s_add_u32 m0, s66, 147456
    s_nop 0
    buffer_load_dwordx4 v8, s[20:23], s63 offen offset:0  lds
    buffer_load_dwordx4 v9, s[20:23], s63 offen offset:1024  lds
    buffer_load_dwordx4 v10, s[20:23], s63 offen offset:2048  lds
    buffer_load_dwordx4 v11, s[20:23], s63 offen offset:3072  lds
    s_waitcnt vmcnt(12)
    s_barrier
    s_and_b32 s3, s44, 3
    s_mul_i32 s3, s3, 5
    s_add_u32 s3, s3, s59
    s_lshl_b32 s64, s46, 8
    s_add_u32 s3, s3, s64
    s_cmp_lg_u32 s3, s60
    s_cbranch_scc1 L_nl_1
    s_mov_b64 exec, 1
    buffer_store_dword v29, off, s[36:39], s59 sc1
    s_mov_b64 exec, -1
L_nl_1:
    s_add_u32 s61, s67, 384
    s_add_u32 s62, s68, 1572864
    s_add_u32 s63, s62, 256
    s_add_u32 m0, s66, 16384
    s_nop 0
    buffer_load_dwordx4 v4, s[8:11], s61 offen offset:0  lds
    buffer_load_dwordx4 v5, s[8:11], s61 offen offset:1024  lds
    buffer_load_dwordx4 v6, s[8:11], s61 offen offset:2048  lds
    buffer_load_dwordx4 v7, s[8:11], s61 offen offset:3072  lds
    s_add_u32 m0, s66, 32768
    s_nop 0
    buffer_load_dwordx4 v8, s[20:23], s62 offen offset:0  lds
    buffer_load_dwordx4 v9, s[20:23], s62 offen offset:1024  lds
    buffer_load_dwordx4 v10, s[20:23], s62 offen offset:2048  lds
    buffer_load_dwordx4 v11, s[20:23], s62 offen offset:3072  lds
    s_add_u32 m0, s66, 49152
    s_nop 0
    buffer_load_dwordx4 v8, s[20:23], s63 offen offset:0  lds
    buffer_load_dwordx4 v9, s[20:23], s63 offen offset:1024  lds
    buffer_load_dwordx4 v10, s[20:23], s63 offen offset:2048  lds
    buffer_load_dwordx4 v11, s[20:23], s63 offen offset:3072  lds
    s_waitcnt vmcnt(12)
    s_barrier
    s_add_u32 s61, s67, 512
    s_add_u32 s62, s68, 2097152
    s_add_u32 s63, s62, 256
    s_add_u32 m0, s66, 65536
    s_nop 0
    buffer_load_dwordx4 v4, s[8:11], s61 offen offset:0  lds
    buffer_load_dwordx4 v5, s[8:11], s61 offen offset:1024  lds
    buffer_load_dwordx4 v6, s[8:11], s61 offen offset:2048  lds
    buffer_load_dwordx4 v7, s[8:11], s61 offen offset:3072  lds
    s_add_u32 m0, s66, 81920
    s_nop 0
    buffer_load_dwordx4 v8, s[20:23], s62 offen offset:0  lds
    buffer_load_dwordx4 v9, s[20:23], s62 offen offset:1024  lds
    buffer_load_dwordx4 v10, s[20:23], s62 offen offset:2048  lds
    buffer_load_dwordx4 v11, s[20:23], s62 offen offset:3072  lds
    s_add_u32 m0, s66, 98304
    s_nop 0
    buffer_load_dwordx4 v8, s[20:23], s63 offen offset:0  lds
    buffer_load_dwordx4 v9, s[20:23], s63 offen offset:1024  lds
    buffer_load_dwordx4 v10, s[20:23], s63 offen offset:2048  lds
    buffer_load_dwordx4 v11, s[20:23], s63 offen offset:3072  lds
    s_waitcnt vmcnt(12)
    s_barrier
    s_add_u32 s61, s67, 640
    s_add_u32 s62, s68, 2621440
    s_add_u32 s63, s62, 256
    s_add_u32 m0, s66, 114688
    s_nop 0
    buffer_load_dwordx4 v4, s[8:11], s61 offen offset:0  lds
    buffer_load_dwordx4 v5, s[8:11], s61 offen offset:1024  lds
    buffer_load_dwordx4 v6, s[8:11], s61 offen offset:2048  lds
    buffer_load_dwordx4 v7, s[8:11], s61 offen offset:3072  lds
    s_add_u32 m0, s66, 131072
    s_nop 0
    buffer_load_dwordx4 v8, s[20:23], s62 offen offset:0  lds
    buffer_load_dwordx4 v9, s[20:23], s62 offen offset:1024  lds
    buffer_load_dwordx4 v10, s[20:23], s62 offen offset:2048  lds
    buffer_load_dwordx4 v11, s[20:23], s62 offen offset:3072  lds
    s_add_u32 m0, s66, 147456
    s_nop 0
    buffer_load_dwordx4 v8, s[20:23], s63 offen offset:0  lds
    buffer_load_dwordx4 v9, s[20:23], s63 offen offset:1024  lds
    buffer_load_dwordx4 v10, s[20:23], s63 offen offset:2048  lds
    buffer_load_dwordx4 v11, s[20:23], s63 offen offset:3072  lds
    s_waitcnt vmcnt(12)
    s_barrier
    s_add_u32 s3, s48, 6
    s_and_b32 s3, s3, 1
    s_or_b32 s3, s3, 6
    s_lshl_b32 s61, s3, 7
    s_add_u32 s61, s61, s67
    s_lshl_b32 s62, s3, 19
    s_add_u32 s62, s62, s68
    s_add_u32 s63, s62, 256
    s_add_u32 m0, s66, 16384
    s_nop 0
    buffer_load_dwordx4 v4, s[8:11], s61 offen offset:0  lds
    buffer_load_dwordx4 v5, s[8:11], s61 offen offset:1024  lds
    buffer_load_dwordx4 v6, s[8:11], s61 offen offset:2048  lds
    buffer_load_dwordx4 v7, s[8:11], s61 offen offset:3072  lds
    s_add_u32 m0, s66, 32768
    s_nop 0
    buffer_load_dwordx4 v8, s[20:23], s62 offen offset:0  lds
    buffer_load_dwordx4 v9, s[20:23], s62 offen offset:1024  lds
    buffer_load_dwordx4 v10, s[20:23], s62 offen offset:2048  lds
    buffer_load_dwordx4 v11, s[20:23], s62 offen offset:3072  lds
    s_add_u32 m0, s66, 49152
    s_nop 0
    buffer_load_dwordx4 v8, s[20:23], s63 offen offset:0  lds
    buffer_load_dwordx4 v9, s[20:23], s63 offen offset:1024  lds
    buffer_load_dwordx4 v10, s[20:23], s63 offen offset:2048  lds
    buffer_load_dwordx4 v11, s[20:23], s63 offen offset:3072  lds
    s_waitcnt vmcnt(12)
    s_barrier
    s_add_u32 s3, s48, 7
    s_and_b32 s3, s3, 1
    s_or_b32 s3, s3, 6
    s_lshl_b32 s61, s3, 7
    s_add_u32 s61, s61, s67
    s_lshl_b32 s62, s3, 19
    s_add_u32 s62, s62, s68
    s_add_u32 s63, s62, 256
    s_add_u32 m0, s66, 65536
    s_nop 0
    buffer_load_dwordx4 v4, s[8:11], s61 offen offset:0  lds
    buffer_load_dwordx4 v5, s[8:11], s61 offen offset:1024  lds
    buffer_load_dwordx4 v6, s[8:11], s61 offen offset:2048  lds
    buffer_load_dwordx4 v7, s[8:11], s61 offen offset:3072  lds
    s_add_u32 m0, s66, 81920
    s_nop 0
    buffer_load_dwordx4 v8, s[20:23], s62 offen offset:0  lds
    buffer_load_dwordx4 v9, s[20:23], s62 offen offset:1024  lds
    buffer_load_dwordx4 v10, s[20:23], s62 offen offset:2048  lds
    buffer_load_dwordx4 v11, s[20:23], s62 offen offset:3072  lds
    s_add_u32 m0, s66, 98304
    s_nop 0
    buffer_load_dwordx4 v8, s[20:23], s63 offen offset:0  lds
    buffer_load_dwordx4 v9, s[20:23], s63 offen offset:1024  lds
    buffer_load_dwordx4 v10, s[20:23], s63 offen offset:2048  lds
    buffer_load_dwordx4 v11, s[20:23], s63 offen offset:3072  lds
    s_load_dwordx2 s[98:99], s[94:95], 0
    s_load_dwordx2 s[98:99], s[94:95], 512
    s_load_dwordx2 s[98:99], s[94:95], 1024
    s_load_dwordx2 s[98:99], s[94:95], 1536
    s_load_dwordx2 s[98:99], s[94:95], 2048
    s_load_dwordx2 s[98:99], s[94:95], 2560
    s_waitcnt vmcnt(12)
    s_barrier
    s_add_u32 s3, s48, 8
    s_and_b32 s3, s3, 1
    s_or_b32 s3, s3, 8
    s_lshl_b32 s61, s3, 7
    s_add_u32 s61, s61, s67
    s_lshl_b32 s62, s3, 19
    s_add_u32 s62, s62, s68
    s_add_u32 s63, s62, 256
    s_add_u32 m0, s66, 114688
    s_nop 0
    buffer_load_dwordx4 v4, s[8:11], s61 offen offset:0  lds
    buffer_load_dwordx4 v5, s[8:11], s61 offen offset:1024  lds
    buffer_load_dwordx4 v6, s[8:11], s61 offen offset:2048  lds
    buffer_load_dwordx4 v7, s[8:11], s61 offen offset:3072  lds
    s_add_u32 m0, s66, 131072
    s_nop 0
    buffer_load_dwordx4 v8, s[20:23], s62 offen offset:0  lds
    buffer_load_dwordx4 v9, s[20:23], s62 offen offset:1024  lds
    buffer_load_dwordx4 v10, s[20:23], s62 offen offset:2048  lds
    buffer_load_dwordx4 v11, s[20:23], s62 offen offset:3072  lds
    s_add_u32 m0, s66, 147456
    s_nop 0
    buffer_load_dwordx4 v8, s[20:23], s63 offen offset:0  lds
    buffer_load_dwordx4 v9, s[20:23], s63 offen offset:1024  lds
    buffer_load_dwordx4 v10, s[20:23], s63 offen offset:2048  lds
    buffer_load_dwordx4 v11, s[20:23], s63 offen offset:3072  lds
    s_load_dwordx2 s[98:99], s[94:95], 3072
    s_load_dwordx2 s[98:99], s[94:95], 3584
    s_load_dwordx2 s[98:99], s[94:95], 4096
    s_load_dwordx2 s[98:99], s[94:95], 4608
    s_load_dwordx2 s[98:99], s[94:95], 5120
    s_load_dwordx2 s[98:99], s[94:95], 5632
    s_waitcnt vmcnt(12)
    s_barrier
    s_add_u32 s3, s48, 9
    s_and_b32 s3, s3, 1
    s_or_b32 s3, s3, 8
    s_lshl_b32 s61, s3, 7
    s_add_u32 s61, s61, s67
    s_lshl_b32 s62, s3, 19
    s_add_u32 s62, s62, s68
    s_add_u32 s63, s62, 256
    s_add_u32 m0, s66, 16384
    s_nop 0
    buffer_load_dwordx4 v4, s[8:11], s61 offen offset:0  lds
    buffer_load_dwordx4 v5, s[8:11], s61 offen offset:1024  lds
    buffer_load_dwordx4 v6, s[8:11], s61 offen offset:2048  lds
    buffer_load_dwordx4 v7, s[8:11], s61 offen offset:3072  lds
    s_add_u32 m0, s66, 32768
    s_nop 0
    buffer_load_dwordx4 v8, s[20:23], s62 offen offset:0  lds
    buffer_load_dwordx4 v9, s[20:23], s62 offen offset:1024  lds
    buffer_load_dwordx4 v10, s[20:23], s62 offen offset:2048  lds
    buffer_load_dwordx4 v11, s[20:23], s62 offen offset:3072  lds
    s_add_u32 m0, s66, 49152
    s_nop 0
    buffer_load_dwordx4 v8, s[20:23], s63 offen offset:0  lds
    buffer_load_dwordx4 v9, s[20:23], s63 offen offset:1024  lds
    buffer_load_dwordx4 v10, s[20:23], s63 offen offset:2048  lds
    buffer_load_dwordx4 v11, s[20:23], s63 offen offset:3072  lds
    s_load_dwordx2 s[98:99], s[94:95], 6144
    s_load_dwordx2 s[98:99], s[94:95], 6656
    s_load_dwordx2 s[98:99], s[94:95], 7168
    s_load_dwordx2 s[98:99], s[94:95], 7680
    s_load_dwordx2 s[98:99], s[94:95], 8192
    s_load_dwordx2 s[98:99], s[94:95], 8704
    s_waitcnt vmcnt(12)
    s_barrier
    s_add_u32 s3, s48, 10
    s_and_b32 s3, s3, 1
    s_or_b32 s3, s3, 10
    s_lshl_b32 s61, s3, 7
    s_add_u32 s61, s61, s67
    s_lshl_b32 s62, s3, 19
    s_add_u32 s62, s62, s68
    s_add_u32 s63, s62, 256
    s_add_u32 m0, s66, 65536
    s_nop 0
    buffer_load_dwordx4 v4, s[8:11], s61 offen offset:0  lds
    buffer_load_dwordx4 v5, s[8:11], s61 offen offset:1024  lds
    buffer_load_dwordx4 v6, s[8:11], s61 offen offset:2048  lds
    buffer_load_dwordx4 v7, s[8:11], s61 offen offset:3072  lds
    s_add_u32 m0, s66, 81920
    s_nop 0
    buffer_load_dwordx4 v8, s[20:23], s62 offen offset:0  lds
    buffer_load_dwordx4 v9, s[20:23], s62 offen offset:1024  lds
    buffer_load_dwordx4 v10, s[20:23], s62 offen offset:2048  lds
    buffer_load_dwordx4 v11, s[20:23], s62 offen offset:3072  lds
    s_add_u32 m0, s66, 98304
    s_nop 0
    buffer_load_dwordx4 v8, s[20:23], s63 offen offset:0  lds
    buffer_load_dwordx4 v9, s[20:23], s63 offen offset:1024  lds
    buffer_load_dwordx4 v10, s[20:23], s63 offen offset:2048  lds
    buffer_load_dwordx4 v11, s[20:23], s63 offen offset:3072  lds
    s_load_dwordx2 s[98:99], s[94:95], 9216
    s_load_dwordx2 s[98:99], s[94:95], 9728
    s_load_dwordx2 s[98:99], s[94:95], 10240
    s_load_dwordx2 s[98:99], s[94:95], 10752
    s_load_dwordx2 s[98:99], s[94:95], 11264
    s_load_dwordx2 s[98:99], s[94:95], 11776
    s_waitcnt vmcnt(12)
    s_barrier
    s_add_u32 s3, s48, 11
    s_and_b32 s3, s3, 1
    s_or_b32 s3, s3, 10
    s_lshl_b32 s61, s3, 7
    s_add_u32 s61, s61, s67
    s_lshl_b32 s62, s3, 19
    s_add_u32 s62, s62, s68
    s_add_u32 s63, s62, 256
    s_add_u32 m0, s66, 114688
    s_nop 0
    buffer_load_dwordx4 v4, s[8:11], s61 offen offset:0  lds
    buffer_load_dwordx4 v5, s[8:11], s61 offen offset:1024  lds
    buffer_load_dwordx4 v6, s[8:11], s61 offen offset:2048  lds
    buffer_load_dwordx4 v7, s[8:11], s61 offen offset:3072  lds
    s_add_u32 m0, s66, 131072
    s_nop 0
    buffer_load_dwordx4 v8, s[20:23], s62 offen offset:0  lds
    buffer_load_dwordx4 v9, s[20:23], s62 offen offset:1024  lds
    buffer_load_dwordx4 v10, s[20:23], s62 offen offset:2048  lds
    buffer_load_dwordx4 v11, s[20:23], s62 offen offset:3072  lds
    s_add_u32 m0, s66, 147456
    s_nop 0
    buffer_load_dwordx4 v8, s[20:23], s63 offen offset:0  lds
    buffer_load_dwordx4 v9, s[20:23], s63 offen offset:1024  lds
    buffer_load_dwordx4 v10, s[20:23], s63 offen offset:2048  lds
    buffer_load_dwordx4 v11, s[20:23], s63 offen offset:3072  lds
    s_load_dwordx2 s[98:99], s[94:95], 12288
    s_load_dwordx2 s[98:99], s[94:95], 12800
    s_load_dwordx2 s[98:99], s[94:95], 13312
    s_load_dwordx2 s[98:99], s[94:95], 13824
    s_load_dwordx2 s[98:99], s[94:95], 14336
    s_load_dwordx2 s[98:99], s[94:95], 14848
    s_waitcnt vmcnt(12)
    s_barrier
    s_add_u32 s3, s48, 12
    s_and_b32 s3, s3, 1
    s_or_b32 s3, s3, 12
    s_lshl_b32 s61, s3, 7
    s_add_u32 s61, s61, s67
    s_lshl_b32 s62, s3, 19
    s_add_u32 s62, s62, s68
    s_add_u32 s63, s62, 256
    s_add_u32 m0, s66, 16384
    s_nop 0
    buffer_load_dwordx4 v4, s[8:11], s61 offen offset:0  lds
    buffer_load_dwordx4 v5, s[8:11], s61 offen offset:1024  lds
    buffer_load_dwordx4 v6, s[8:11], s61 offen offset:2048  lds
    buffer_load_dwordx4 v7, s[8:11], s61 offen offset:3072  lds
    s_add_u32 m0, s66, 32768
    s_nop 0
    buffer_load_dwordx4 v8, s[20:23], s62 offen offset:0  lds
    buffer_load_dwordx4 v9, s[20:23], s62 offen offset:1024  lds
    buffer_load_dwordx4 v10, s[20:23], s62 offen offset:2048  lds
    buffer_load_dwordx4 v11, s[20:23], s62 offen offset:3072  lds
    s_add_u32 m0, s66, 49152
    s_nop 0
    buffer_load_dwordx4 v8, s[20:23], s63 offen offset:0  lds
    buffer_load_dwordx4 v9, s[20:23], s63 offen offset:1024  lds
    buffer_load_dwordx4 v10, s[20:23], s63 offen offset:2048  lds
    buffer_load_dwordx4 v11, s[20:23], s63 offen offset:3072  lds
    s_load_dwordx2 s[98:99], s[94:95], 15360
    s_load_dwordx2 s[98:99], s[94:95], 15872
    s_load_dwordx2 s[98:99], s[96:97], 0
    s_load_dwordx2 s[98:99], s[96:97], 512
    s_load_dwordx2 s[98:99], s[96:97], 1024
    s_load_dwordx2 s[98:99], s[96:97], 1536
    s_waitcnt vmcnt(12)
    s_barrier
    s_add_u32 s3, s48, 13
    s_and_b32 s3, s3, 1
    s_or_b32 s3, s3, 12
    s_lshl_b32 s61, s3, 7
    s_add_u32 s61, s61, s67
    s_lshl_b32 s62, s3, 19
    s_add_u32 s62, s62, s68
    s_add_u32 s63, s62, 256
    s_add_u32 m0, s66, 65536
    s_nop 0
    buffer_load_dwordx4 v4, s[8:11], s61 offen offset:0  lds
    buffer_load_dwordx4 v5, s[8:11], s61 offen offset:1024  lds
    buffer_load_dwordx4 v6, s[8:11], s61 offen offset:2048  lds
    buffer_load_dwordx4 v7, s[8:11], s61 offen offset:3072  lds
    s_add_u32 m0, s66, 81920
    s_nop 0
    buffer_load_dwordx4 v8, s[20:23], s62 offen offset:0  lds
    buffer_load_dwordx4 v9, s[20:23], s62 offen offset:1024  lds
    buffer_load_dwordx4 v10, s[20:23], s62 offen offset:2048  lds
    buffer_load_dwordx4 v11, s[20:23], s62 offen offset:3072  lds
    s_add_u32 m0, s66, 98304
    s_nop 0
    buffer_load_dwordx4 v8, s[20:23], s63 offen offset:0  lds
    buffer_load_dwordx4 v9, s[20:23], s63 offen offset:1024  lds
    buffer_load_dwordx4 v10, s[20:23], s63 offen offset:2048  lds
    buffer_load_dwordx4 v11, s[20:23], s63 offen offset:3072  lds
    s_load_dwordx2 s[98:99], s[96:97], 2048
    s_load_dwordx2 s[98:99], s[96:97], 2560
    s_load_dwordx2 s[98:99], s[96:97], 3072
    s_load_dwordx2 s[98:99], s[96:97], 3584
    s_load_dwordx2 s[98:99], s[96:97], 4096
    s_load_dwordx2 s[98:99], s[96:97], 4608
    s_waitcnt vmcnt(12)
    s_barrier
    s_add_u32 s3, s48, 14
    s_and_b32 s3, s3, 1
    s_or_b32 s3, s3, 14
    s_lshl_b32 s61, s3, 7
    s_add_u32 s61, s61, s67
    s_lshl_b32 s62, s3, 19
    s_add_u32 s62, s62, s68
    s_add_u32 s63, s62, 256
    s_add_u32 m0, s66, 114688
    s_nop 0
    buffer_load_dwordx4 v4, s[8:11], s61 offen offset:0  lds
    buffer_load_dwordx4 v5, s[8:11], s61 offen offset:1024  lds
    buffer_load_dwordx4 v6, s[8:11], s61 offen offset:2048  lds
    buffer_load_dwordx4 v7, s[8:11], s61 offen offset:3072  lds
    s_add_u32 m0, s66, 131072
    s_nop 0
    buffer_load_dwordx4 v8, s[20:23], s62 offen offset:0  lds
    buffer_load_dwordx4 v9, s[20:23], s62 offen offset:1024  lds
    buffer_load_dwordx4 v10, s[20:23], s62 offen offset:2048  lds
    buffer_load_dwordx4 v11, s[20:23], s62 offen offset:3072  lds
    s_add_u32 m0, s66, 147456
    s_nop 0
    buffer_load_dwordx4 v8, s[20:23], s63 offen offset:0  lds
    buffer_load_dwordx4 v9, s[20:23], s63 offen offset:1024  lds
    buffer_load_dwordx4 v10, s[20:23], s63 offen offset:2048  lds
    buffer_load_dwordx4 v11, s[20:23], s63 offen offset:3072  lds
    s_load_dwordx2 s[98:99], s[96:97], 5120
    s_load_dwordx2 s[98:99], s[96:97], 5632
    s_load_dwordx2 s[98:99], s[96:97], 6144
    s_load_dwordx2 s[98:99], s[96:97], 6656
    s_load_dwordx2 s[98:99], s[96:97], 7168
    s_load_dwordx2 s[98:99], s[96:97], 7680
    s_waitcnt vmcnt(12)
    s_barrier
    s_add_u32 s3, s48, 15
    s_and_b32 s3, s3, 1
    s_or_b32 s3, s3, 14
    s_lshl_b32 s61, s3, 7
    s_add_u32 s61, s61, s67
    s_lshl_b32 s62, s3, 19
    s_add_u32 s62, s62, s68
    s_add_u32 s63, s62, 256
    s_add_u32 m0, s66, 16384
    s_nop 0
    buffer_load_dwordx4 v4, s[8:11], s61 offen offset:0  lds
    buffer_load_dwordx4 v5, s[8:11], s61 offen offset:1024  lds
    buffer_load_dwordx4 v6, s[8:11], s61 offen offset:2048  lds
    buffer_load_dwordx4 v7, s[8:11], s61 offen offset:3072  lds
    s_add_u32 m0, s66, 32768
    s_nop 0
    buffer_load_dwordx4 v8, s[20:23], s62 offen offset:0  lds
    buffer_load_dwordx4 v9, s[20:23], s62 offen offset:1024  lds
    buffer_load_dwordx4 v10, s[20:23], s62 offen offset:2048  lds
    buffer_load_dwordx4 v11, s[20:23], s62 offen offset:3072  lds
    s_add_u32 m0, s66, 49152
    s_nop 0
    buffer_load_dwordx4 v8, s[20:23], s63 offen offset:0  lds
    buffer_load_dwordx4 v9, s[20:23], s63 offen offset:1024  lds
    buffer_load_dwordx4 v10, s[20:23], s63 offen offset:2048  lds
    buffer_load_dwordx4 v11, s[20:23], s63 offen offset:3072  lds
    s_waitcnt vmcnt(12)
    s_barrier
    s_add_u32 s3, s88, 0
    s_and_b32 s3, s3, 0x1ffff
    s_add_u32 s61, s3, s69
    s_add_u32 m0, s66, 81920
    s_nop 0
    buffer_load_dwordx4 v12, s[12:15], s61 offen offset:0 nt lds
    buffer_load_dwordx4 v12, s[12:15], s61 offen offset:1024 nt lds
    buffer_load_dwordx4 v13, s[12:15], s61 offen offset:2048 nt lds
    buffer_load_dwordx4 v13, s[12:15], s61 offen offset:3072 nt lds
    s_add_u32 s3, s88, 0
    s_and_b32 s3, s3, 0x1ffff
    s_add_u32 s61, s3, s69
    s_add_u32 m0, s66, 65536
    s_nop 0
    buffer_load_dwordx4 v16, s[16:19], s61 offen offset:0 nt lds
    buffer_load_dwordx4 v16, s[16:19], s61 offen offset:1024 nt lds
    buffer_load_dwordx4 v17, s[16:19], s61 offen offset:2048 nt lds
    buffer_load_dwordx4 v17, s[16:19], s61 offen offset:3072 nt lds
    s_add_u32 s3, s88, 16384
    s_and_b32 s3, s3, 0x1ffff
    s_add_u32 s64, s3, s89
    buffer_load_dwordx4 v[96:99], v16, s[16:19], s64 offen offset:0 nt
    buffer_load_dwordx4 v[100:103], v16, s[16:19], s64 offen offset:1024 nt
    buffer_load_dwordx4 v[104:107], v17, s[16:19], s64 offen offset:2048 nt
    buffer_load_dwordx4 v[108:111], v17, s[16:19], s64 offen offset:3072 nt
    s_waitcnt vmcnt(12)
    s_barrier
    s_add_u32 s3, s88, 16384
    s_and_b32 s3, s3, 0x1ffff
    s_add_u32 s61, s3, s69
    s_add_u32 m0, s66, 114688
    s_nop 0
    buffer_load_dwordx4 v12, s[12:15], s61 offen offset:0 nt lds
    buffer_load_dwordx4 v12, s[12:15], s61 offen offset:1024 nt lds
    buffer_load_dwordx4 v13, s[12:15], s61 offen offset:2048 nt lds
    buffer_load_dwordx4 v13, s[12:15], s61 offen offset:3072 nt lds
    s_barrier
    s_add_u32 s3, s88, 65536
    s_and_b32 s3, s3, 0x1ffff
    s_add_u32 s64, s3, s89
    buffer_load_dwordx4 v[112:115], v16, s[16:19], s64 offen offset:0 nt
    buffer_load_dwordx4 v[116:119], v16, s[16:19], s64 offen offset:1024 nt
    buffer_load_dwordx4 v[120:123], v17, s[16:19], s64 offen offset:2048 nt
    buffer_load_dwordx4 v[124:127], v17, s[16:19], s64 offen offset:3072 nt
    s_add_u32 s3, s88, 98304
    s_and_b32 s3, s3, 0x1ffff
    s_add_u32 s64, s3, s89
    buffer_load_dwordx4 v[128:131], v16, s[16:19], s64 offen offset:0 nt
    buffer_load_dwordx4 v[132:135], v16, s[16:19], s64 offen offset:1024 nt
    buffer_load_dwordx4 v[136:139], v17, s[16:19], s64 offen offset:2048 nt
    buffer_load_dwordx4 v[140:143], v17, s[16:19], s64 offen offset:3072 nt
    s_barrier
    s_add_u32 s3, s88, 32768
    s_and_b32 s3, s3, 0x1ffff
    s_add_u32 s61, s3, s69
    s_add_u32 m0, s66, 147456
    s_nop 0
    buffer_load_dwordx4 v12, s[12:15], s61 offen offset:0 nt lds
    buffer_load_dwordx4 v12, s[12:15], s61 offen offset:1024 nt lds
    buffer_load_dwordx4 v13, s[12:15], s61 offen offset:2048 nt lds
    buffer_load_dwordx4 v13, s[12:15], s61 offen offset:3072 nt lds
    s_waitcnt lgkmcnt(0)
    s_waitcnt vmcnt(24)
    s_barrier
    s_waitcnt vmcnt(12)
    s_barrier
    s_add_u32 s3, s88, 16384
    s_and_b32 s3, s3, 0x1ffff
    s_add_u32 s61, s3, s69
    s_add_u32 m0, s66, 98304
    s_nop 0
    buffer_load_dwordx4 v16, s[16:19], s61 offen offset:0 nt lds
    buffer_load_dwordx4 v16, s[16:19], s61 offen offset:1024 nt lds
    buffer_load_dwordx4 v17, s[16:19], s61 offen offset:2048 nt lds
    buffer_load_dwordx4 v17, s[16:19], s61 offen offset:3072 nt lds
    s_barrier
    s_add_u32 s3, s88, 49152
    s_and_b32 s3, s3, 0x1ffff
    s_add_u32 s61, s3, s69
    s_add_u32 m0, s66, 81920
    s_nop 0
    buffer_load_dwordx4 v12, s[12:15], s61 offen offset:0 nt lds
    buffer_load_dwordx4 v12, s[12:15], s61 offen offset:1024 nt lds
    buffer_load_dwordx4 v13, s[12:15], s61 offen offset:2048 nt lds
    buffer_load_dwordx4 v13, s[12:15], s61 offen offset:3072 nt lds
    s_add_u32 s3, s88, 32768
    s_and_b32 s3, s3, 0x1ffff
    s_add_u32 s61, s3, s69
    s_add_u32 m0, s66, 131072
    s_nop 0
    buffer_load_dwordx4 v16, s[16:19], s61 offen offset:0 nt lds
    buffer_load_dwordx4 v16, s[16:19], s61 offen offset:1024 nt lds
    buffer_load_dwordx4 v17, s[16:19], s61 offen offset:2048 nt lds
    buffer_load_dwordx4 v17, s[16:19], s61 offen offset:3072 nt lds
    s_waitcnt vmcnt(12)
    s_barrier
    s_add_u32 s3, s88, 65536
    s_and_b32 s3, s3, 0x1ffff
    s_add_u32 s61, s3, s69
    s_add_u32 m0, s66, 114688
    s_nop 0
    buffer_load_dwordx4 v12, s[12:15], s61 offen offset:0 nt lds
    buffer_load_dwordx4 v12, s[12:15], s61 offen offset:1024 nt lds
    buffer_load_dwordx4 v13, s[12:15], s61 offen offset:2048 nt lds
    buffer_load_dwordx4 v13, s[12:15], s61 offen offset:3072 nt lds
    s_waitcnt vmcnt(12)
    s_barrier
    s_add_u32 s3, s88, 49152
    s_and_b32 s3, s3, 0x1ffff
    s_add_u32 s61, s3, s69
    s_add_u32 m0, s66, 65536
    s_nop 0
    buffer_load_dwordx4 v16, s[16:19], s61 offen offset:0 nt lds
    buffer_load_dwordx4 v16, s[16:19], s61 offen offset:1024 nt lds
    buffer_load_dwordx4 v17, s[16:19], s61 offen offset:2048 nt lds
    buffer_load_dwordx4 v17, s[16:19], s61 offen offset:3072 nt lds
    s_waitcnt vmcnt(12)
    s_barrier
    s_add_u32 s3, s88, 81920
    s_and_b32 s3, s3, 0x1ffff
    s_add_u32 s61, s3, s69
    s_add_u32 m0, s66, 147456
    s_nop 0
    buffer_load_dwordx4 v12, s[12:15], s61 offen offset:0 nt lds
    buffer_load_dwordx4 v12, s[12:15], s61 offen offset:1024 nt lds
    buffer_load_dwordx4 v13, s[12:15], s61 offen offset:2048 nt lds
    buffer_load_dwordx4 v13, s[12:15], s61 offen offset:3072 nt lds
    s_waitcnt vmcnt(12)
    s_barrier
    s_add_u32 s3, s88, 65536
    s_and_b32 s3, s3, 0x1ffff
    s_add_u32 s61, s3, s69
    s_add_u32 m0, s66, 98304
    s_nop 0
    buffer_load_dwordx4 v16, s[16:19], s61 offen offset:0 nt lds
    buffer_load_dwordx4 v16, s[16:19], s61 offen offset:1024 nt lds
    buffer_load_dwordx4 v17, s[16:19], s61 offen offset:2048 nt lds
    buffer_load_dwordx4 v17, s[16:19], s61 offen offset:3072 nt lds
    buffer_load_dword v25, off, s[36:39], s59 sc1
    s_waitcnt vmcnt(13)
    s_barrier
    s_add_u32 s3, s88, 98304
    s_and_b32 s3, s3, 0x1ffff
    s_add_u32 s61, s3, s69
    s_add_u32 m0, s66, 81920
    s_nop 0
    buffer_load_dwordx4 v12, s[12:15], s61 offen offset:0 nt lds
    buffer_load_dwordx4 v12, s[12:15], s61 offen offset:1024 nt lds
    buffer_load_dwordx4 v13, s[12:15], s61 offen offset:2048 nt lds
    buffer_load_dwordx4 v13, s[12:15], s61 offen offset:3072 nt lds
    s_waitcnt vmcnt(13)
    s_barrier
    s_add_u32 s3, s88, 81920
    s_and_b32 s3, s3, 0x1ffff
    s_add_u32 s61, s3, s69
    s_add_u32 m0, s66, 131072
    s_nop 0
    buffer_load_dwordx4 v16, s[16:19], s61 offen offset:0 nt lds
    buffer_load_dwordx4 v16, s[16:19], s61 offen offset:1024 nt lds
    buffer_load_dwordx4 v17, s[16:19], s61 offen offset:2048 nt lds
    buffer_load_dwordx4 v17, s[16:19], s61 offen offset:3072 nt lds
    s_waitcnt vmcnt(13)
    s_barrier
    s_add_u32 s3, s88, 114688
    s_and_b32 s3, s3, 0x1ffff
    s_add_u32 s61, s3, s69
    s_add_u32 m0, s66, 114688
    s_nop 0
    buffer_load_dwordx4 v12, s[12:15], s61 offen offset:0 nt lds
    buffer_load_dwordx4 v12, s[12:15], s61 offen offset:1024 nt lds
    buffer_load_dwordx4 v13, s[12:15], s61 offen offset:2048 nt lds
    buffer_load_dwordx4 v13, s[12:15], s61 offen offset:3072 nt lds
    s_waitcnt vmcnt(13)
    s_barrier
    s_add_u32 s3, s88, 98304
    s_and_b32 s3, s3, 0x1ffff
    s_add_u32 s61, s3, s69
    s_add_u32 m0, s66, 65536
    s_nop 0
    buffer_load_dwordx4 v16, s[16:19], s61 offen offset:0 nt lds
    buffer_load_dwordx4 v16, s[16:19], s61 offen offset:1024 nt lds
    buffer_load_dwordx4 v17, s[16:19], s61 offen offset:2048 nt lds
    buffer_load_dwordx4 v17, s[16:19], s61 offen offset:3072 nt lds
    s_waitcnt vmcnt(12)
    s_barrier
    s_add_u32 s3, s88, 0
    s_and_b32 s3, s3, 0x1ffff
    s_add_u32 s61, s3, s89
    s_add_u32 m0, s66, 147456
    s_nop 0
    buffer_load_dwordx4 v12, s[12:15], s61 offen offset:0 nt lds
    buffer_load_dwordx4 v12, s[12:15], s61 offen offset:1024 nt lds
    buffer_load_dwordx4 v13, s[12:15], s61 offen offset:2048 nt lds
    buffer_load_dwordx4 v13, s[12:15], s61 offen offset:3072 nt lds
    s_waitcnt vmcnt(12)
    s_barrier
    s_add_u32 s3, s88, 114688
    s_and_b32 s3, s3, 0x1ffff
    s_add_u32 s61, s3, s69
    s_add_u32 m0, s66, 98304
    s_nop 0
    buffer_load_dwordx4 v16, s[16:19], s61 offen offset:0 nt lds
    buffer_load_dwordx4 v16, s[16:19], s61 offen offset:1024 nt lds
    buffer_load_dwordx4 v17, s[16:19], s61 offen offset:2048 nt lds
    buffer_load_dwordx4 v17, s[16:19], s61 offen offset:3072 nt lds
    s_mov_b32 s72, 0
L_ps_3:
    v_cmp_ne_u32 vcc, 1, v25
    s_cbranch_vccz L_pd_2
    s_sleep 4
    buffer_load_dword v25, off, s[36:39], s59 sc1
    s_add_u32 s72, s72, 1
    s_waitcnt vmcnt(0)
    s_cmp_lt_u32 s72, 0x40000
    s_cbranch_scc1 L_ps_3
L_pd_2:
    s_waitcnt vmcnt(12)
    s_barrier
    s_add_u32 s3, s88, 16384
    s_and_b32 s3, s3, 0x1ffff
    s_add_u32 s61, s3, s89
    s_add_u32 m0, s66, 81920
    s_nop 0
    buffer_load_dwordx4 v12, s[12:15], s61 offen offset:0 nt lds
    buffer_load_dwordx4 v12, s[12:15], s61 offen offset:1024 nt lds
    buffer_load_dwordx4 v13, s[12:15], s61 offen offset:2048 nt lds
    buffer_load_dwordx4 v13, s[12:15], s61 offen offset:3072 nt lds
    s_waitcnt vmcnt(12)
    s_barrier
    s_add_u32 s3, s88, 0
    s_and_b32 s3, s3, 0x1ffff
    s_add_u32 s61, s3, s89
    s_add_u32 m0, s66, 131072
    s_nop 0
    buffer_load_dwordx4 v16, s[16:19], s61 offen offset:0 nt lds
    buffer_load_dwordx4 v16, s[16:19], s61 offen offset:1024 nt lds
    buffer_load_dwordx4 v17, s[16:19], s61 offen offset:2048 nt lds
    buffer_load_dwordx4 v17, s[16:19], s61 offen offset:3072 nt lds
    s_waitcnt vmcnt(12)
    s_barrier
    s_add_u32 s3, s88, 32768
    s_and_b32 s3, s3, 0x1ffff
    s_add_u32 s61, s3, s89
    s_add_u32 m0, s66, 114688
    s_nop 0
    buffer_load_dwordx4 v12, s[12:15], s61 offen offset:0 nt lds
    buffer_load_dwordx4 v12, s[12:15], s61 offen offset:1024 nt lds
    buffer_load_dwordx4 v13, s[12:15], s61 offen offset:2048 nt lds
    buffer_load_dwordx4 v13, s[12:15], s61 offen offset:3072 nt lds
    s_waitcnt vmcnt(12)
    s_barrier
    v_add_u32 v30, 65536, v24
    ds_write_b128 v30, v[96:99] offset:0
    s_waitcnt lgkmcnt(0)
    ds_write_b128 v30, v[100:103] offset:1024
    s_waitcnt lgkmcnt(0)
    ds_write_b128 v30, v[104:107] offset:2048
    s_waitcnt lgkmcnt(0)
    ds_write_b128 v30, v[108:111] offset:3072
    s_waitcnt lgkmcnt(0)
    s_waitcnt vmcnt(8)
    s_barrier
    s_waitcnt vmcnt(4)
    s_barrier
    s_add_u32 s3, s88, 49152
    s_and_b32 s3, s3, 0x1ffff
    s_add_u32 s61, s3, s89
    s_add_u32 m0, s66, 147456
    s_nop 0
    buffer_load_dwordx4 v12, s[12:15], s61 offen offset:0 nt lds
    buffer_load_dwordx4 v12, s[12:15], s61 offen offset:1024 nt lds
    buffer_load_dwordx4 v13, s[12:15], s61 offen offset:2048 nt lds
    buffer_load_dwordx4 v13, s[12:15], s61 offen offset:3072 nt lds
    s_add_u32 s3, s88, 32768
    s_and_b32 s3, s3, 0x1ffff
    s_add_u32 s61, s3, s89
    s_add_u32 m0, s66, 98304
    s_nop 0
    buffer_load_dwordx4 v16, s[16:19], s61 offen offset:0 nt lds
    buffer_load_dwordx4 v16, s[16:19], s61 offen offset:1024 nt lds
    buffer_load_dwordx4 v17, s[16:19], s61 offen offset:2048 nt lds
    buffer_load_dwordx4 v17, s[16:19], s61 offen offset:3072 nt lds
    v_add_u32 v30, 0, v24
    ds_read_b128 v[32:35], v30 offset:0
    ds_read_b128 v[36:39], v30 offset:1024
    ds_read_b128 v[40:43], v30 offset:2048
    ds_read_b128 v[44:47], v30 offset:3072
    v_add_u32 v31, 16384, v24
    ds_read_b128 v[48:51], v31 offset:0
    ds_read_b128 v[52:55], v31 offset:1024
    ds_read_b128 v[56:59], v31 offset:2048
    ds_read_b128 v[60:63], v31 offset:3072
    s_waitcnt lgkmcnt(0)
    s_add_u32 s64, s73, 0
    buffer_store_dwordx4 v[32:35], v24, s[32:35], s64 offen offset:0 sc1
    buffer_store_dwordx4 v[36:39], v24, s[32:35], s64 offen offset:1024 sc1
    buffer_store_dwordx4 v[40:43], v24, s[32:35], s64 offen offset:2048 sc1
    buffer_store_dwordx4 v[44:47], v24, s[32:35], s64 offen offset:3072 sc1
    s_waitcnt vmcnt(12)
    s_barrier
    s_add_u32 s3, s88, 65536
    s_and_b32 s3, s3, 0x1ffff
    s_add_u32 s61, s3, s89
    s_add_u32 m0, s66, 81920
    s_nop 0
    buffer_load_dwordx4 v12, s[12:15], s61 offen offset:0 nt lds
    buffer_load_dwordx4 v12, s[12:15], s61 offen offset:1024 nt lds
    buffer_load_dwordx4 v13, s[12:15], s61 offen offset:2048 nt lds
    buffer_load_dwordx4 v13, s[12:15], s61 offen offset:3072 nt lds
    s_barrier
    s_add_u32 s3, s88, 49152
    s_and_b32 s3, s3, 0x1ffff
    s_add_u32 s61, s3, s89
    s_add_u32 m0, s66, 131072
    s_nop 0
    buffer_load_dwordx4 v16, s[16:19], s61 offen offset:0 nt lds
    buffer_load_dwordx4 v16, s[16:19], s61 offen offset:1024 nt lds
    buffer_load_dwordx4 v17, s[16:19], s61 offen offset:2048 nt lds
    buffer_load_dwordx4 v17, s[16:19], s61 offen offset:3072 nt lds
    s_add_u32 s64, s73, 16384
    buffer_store_dwordx4 v[48:51], v24, s[32:35], s64 offen offset:0 sc1
    buffer_store_dwordx4 v[52:55], v24, s[32:35], s64 offen offset:1024 sc1
    buffer_store_dwordx4 v[56:59], v24, s[32:35], s64 offen offset:2048 sc1
    buffer_store_dwordx4 v[60:63], v24, s[32:35], s64 offen offset:3072 sc1
    s_waitcnt vmcnt(20)
    s_barrier
    s_add_u32 s3, s88, 81920
    s_and_b32 s3, s3, 0x1ffff
    s_add_u32 s61, s3, s89
    s_add_u32 m0, s66, 114688
    s_nop 0
    buffer_load_dwordx4 v12, s[12:15], s61 offen offset:0 nt lds
    buffer_load_dwordx4 v12, s[12:15], s61 offen offset:1024 nt lds
    buffer_load_dwordx4 v13, s[12:15], s61 offen offset:2048 nt lds
    buffer_load_dwordx4 v13, s[12:15], s61 offen offset:3072 nt lds
    s_waitcnt vmcnt(20)
    s_barrier
    v_add_u32 v30, 65536, v24
    ds_write_b128 v30, v[112:115] offset:0
    s_waitcnt lgkmcnt(0)
    ds_write_b128 v30, v[116:119] offset:1024
    s_waitcnt lgkmcnt(0)
    ds_write_b128 v30, v[120:123] offset:2048
    s_waitcnt lgkmcnt(0)
    ds_write_b128 v30, v[124:127] offset:3072
    s_waitcnt lgkmcnt(0)
    s_waitcnt vmcnt(12)
    s_barrier
    s_add_u32 s3, s88, 98304
    s_and_b32 s3, s3, 0x1ffff
    s_add_u32 s61, s3, s89
    s_add_u32 m0, s66, 147456
    s_nop 0
    buffer_load_dwordx4 v12, s[12:15], s61 offen offset:0 nt lds
    buffer_load_dwordx4 v12, s[12:15], s61 offen offset:1024 nt lds
    buffer_load_dwordx4 v13, s[12:15], s61 offen offset:2048 nt lds
    buffer_load_dwordx4 v13, s[12:15], s61 offen offset:3072 nt lds
    s_waitcnt vmcnt(12)
    s_barrier
    s_add_u32 s3, s88, 81920
    s_and_b32 s3, s3, 0x1ffff
    s_add_u32 s61, s3, s89
    s_add_u32 m0, s66, 98304
    s_nop 0
    buffer_load_dwordx4 v16, s[16:19], s61 offen offset:0 nt lds
    buffer_load_dwordx4 v16, s[16:19], s61 offen offset:1024 nt lds
    buffer_load_dwordx4 v17, s[16:19], s61 offen offset:2048 nt lds
    buffer_load_dwordx4 v17, s[16:19], s61 offen offset:3072 nt lds
    s_waitcnt vmcnt(12)
    s_and_b32 s64, s60, -4
    s_lshl_b32 s64, s64, 10
    s_lshl_b32 s3, s71, 4
    s_add_u32 s64, s64, s3
    s_lshl_b32 s3, s46, 2
    s_add_u32 s64, s64, s3
    s_add_u32 s64, s64, 31457280
    s_mov_b64 exec, 15
    buffer_store_dword v29, v28, s[32:35], s64 offen sc1
    s_mov_b64 exec, -1
    s_waitcnt vmcnt(9)
    s_barrier
    s_add_u32 s3, s88, 114688
    s_and_b32 s3, s3, 0x1ffff
    s_add_u32 s61, s3, s89
    s_add_u32 m0, s66, 81920
    s_nop 0
    buffer_load_dwordx4 v12, s[12:15], s61 offen offset:0 nt lds
    buffer_load_dwordx4 v12, s[12:15], s61 offen offset:1024 nt lds
    buffer_load_dwordx4 v13, s[12:15], s61 offen offset:2048 nt lds
    buffer_load_dwordx4 v13, s[12:15], s61 offen offset:3072 nt lds
    s_barrier
    v_add_u32 v30, 131072, v24
    ds_write_b128 v30, v[128:131] offset:0
    s_waitcnt lgkmcnt(0)
    ds_write_b128 v30, v[132:135] offset:1024
    s_waitcnt lgkmcnt(0)
    ds_write_b128 v30, v[136:139] offset:2048
    s_waitcnt lgkmcnt(0)
    ds_write_b128 v30, v[140:143] offset:3072
    s_waitcnt lgkmcnt(0)
    s_waitcnt vmcnt(9)
    s_barrier
    s_waitcnt vmcnt(5)
    s_barrier
    s_add_u32 s3, s88, 114688
    s_and_b32 s3, s3, 0x1ffff
    s_add_u32 s61, s3, s89
    s_add_u32 m0, s66, 65536
    s_nop 0
    buffer_load_dwordx4 v16, s[16:19], s61 offen offset:0 nt lds
    buffer_load_dwordx4 v16, s[16:19], s61 offen offset:1024 nt lds
    buffer_load_dwordx4 v17, s[16:19], s61 offen offset:2048 nt lds
    buffer_load_dwordx4 v17, s[16:19], s61 offen offset:3072 nt lds
    s_add_u32 s61, s84, 262144
    s_add_u32 m0, s66, 32768
    s_nop 0
    buffer_load_dwordx4 v20, s[24:27], s61 offen offset:0  lds
    buffer_load_dwordx4 v21, s[24:27], s61 offen offset:1024  lds
    buffer_load_dwordx4 v22, s[24:27], s61 offen offset:2048  lds
    buffer_load_dwordx4 v23, s[24:27], s61 offen offset:3072  lds
    s_waitcnt vmcnt(8)
    s_barrier
    buffer_load_dword v25, v27, s[32:35], s74 offen offset:0 sc1
    s_add_u32 s61, s84, 262400
    s_add_u32 m0, s66, 49152
    s_nop 0
    buffer_load_dwordx4 v20, s[24:27], s61 offen offset:0  lds
    buffer_load_dwordx4 v21, s[24:27], s61 offen offset:1024  lds
    buffer_load_dwordx4 v22, s[24:27], s61 offen offset:2048  lds
    buffer_load_dwordx4 v23, s[24:27], s61 offen offset:3072  lds
    s_barrier
    s_add_u32 s61, s84, 393472
    s_add_u32 m0, s66, 147456
    s_nop 0
    buffer_load_dwordx4 v20, s[24:27], s61 offen offset:0  lds
    buffer_load_dwordx4 v21, s[24:27], s61 offen offset:1024  lds
    buffer_load_dwordx4 v22, s[24:27], s61 offen offset:2048  lds
    buffer_load_dwordx4 v23, s[24:27], s61 offen offset:3072  lds
    s_barrier
    s_add_u32 s61, s84, 256
    s_add_u32 m0, s66, 98304
    s_nop 0
    buffer_load_dwordx4 v20, s[24:27], s61 offen offset:0  lds
    buffer_load_dwordx4 v21, s[24:27], s61 offen offset:1024  lds
    buffer_load_dwordx4 v22, s[24:27], s61 offen offset:2048  lds
    buffer_load_dwordx4 v23, s[24:27], s61 offen offset:3072  lds
    s_waitcnt vmcnt(17)
    s_barrier
    s_waitcnt vmcnt(12)
    s_mov_b32 s72, 0
L_ps_5:
    v_cmp_ne_u32 vcc, 1, v25
    s_cbranch_vccz L_pd_4
    s_sleep 4
    buffer_load_dword v25, v27, s[32:35], s74 offen offset:0 sc1
    s_add_u32 s72, s72, 1
    s_waitcnt vmcnt(0)
    s_cmp_lt_u32 s72, 0x40000
    s_cbranch_scc1 L_ps_5
L_pd_4:
    s_add_u32 s61, s84, 393216
    s_add_u32 m0, s66, 131072
    s_nop 0
    buffer_load_dwordx4 v20, s[24:27], s61 offen offset:0  lds
    buffer_load_dwordx4 v21, s[24:27], s61 offen offset:1024  lds
    buffer_load_dwordx4 v22, s[24:27], s61 offen offset:2048  lds
    buffer_load_dwordx4 v23, s[24:27], s61 offen offset:3072  lds
    s_add_u32 s61, s84, 0
    s_add_u32 m0, s66, 81920
    s_nop 0
    buffer_load_dwordx4 v20, s[24:27], s61 offen offset:0  lds
    buffer_load_dwordx4 v21, s[24:27], s61 offen offset:1024  lds
    buffer_load_dwordx4 v22, s[24:27], s61 offen offset:2048  lds
    buffer_load_dwordx4 v23, s[24:27], s61 offen offset:3072  lds
    s_waitcnt vmcnt(16)
    s_barrier
    v_add_u32 v30, 16384, v24
    ds_read_b128 v[64:67], v30 offset:0
    ds_read_b128 v[68:71], v30 offset:1024
    ds_read_b128 v[72:75], v30 offset:2048
    ds_read_b128 v[76:79], v30 offset:3072
    v_add_u32 v31, 114688, v24
    ds_read_b128 v[80:83], v31 offset:0
    ds_read_b128 v[84:87], v31 offset:1024
    ds_read_b128 v[88:91], v31 offset:2048
    ds_read_b128 v[92:95], v31 offset:3072
    s_waitcnt lgkmcnt(0)
    s_add_u32 s64, s73, 32768
    buffer_store_dwordx4 v[64:67], v24, s[32:35], s64 offen offset:0 sc1
    buffer_store_dwordx4 v[68:71], v24, s[32:35], s64 offen offset:1024 sc1
    buffer_store_dwordx4 v[72:75], v24, s[32:35], s64 offen offset:2048 sc1
    buffer_store_dwordx4 v[76:79], v24, s[32:35], s64 offen offset:3072 sc1
    s_add_u32 s64, s73, 49152
    buffer_store_dwordx4 v[80:83], v24, s[32:35], s64 offen offset:0 sc1
    buffer_store_dwordx4 v[84:87], v24, s[32:35], s64 offen offset:1024 sc1
    buffer_store_dwordx4 v[88:91], v24, s[32:35], s64 offen offset:2048 sc1
    buffer_store_dwordx4 v[92:95], v24, s[32:35], s64 offen offset:3072 sc1
    v_add_u32 v30, 65536, v24
    ds_write_b128 v30, v[32:35] offset:0
    ds_write_b128 v30, v[36:39] offset:1024
    ds_write_b128 v30, v[40:43] offset:2048
    ds_write_b128 v30, v[44:47] offset:3072
    s_waitcnt vmcnt(12)
    s_waitcnt lgkmcnt(0)
    s_barrier
    s_add_u32 s61, s84, 131072
    s_add_u32 m0, s66, 32768
    s_nop 0
    buffer_load_dwordx4 v20, s[24:27], s61 offen offset:0  lds
    buffer_load_dwordx4 v21, s[24:27], s61 offen offset:1024  lds
    buffer_load_dwordx4 v22, s[24:27], s61 offen offset:2048  lds
    buffer_load_dwordx4 v23, s[24:27], s61 offen offset:3072  lds
    s_add_u32 s61, s84, 131328
    s_add_u32 m0, s66, 49152
    s_nop 0
    buffer_load_dwordx4 v20, s[24:27], s61 offen offset:0  lds
    buffer_load_dwordx4 v21, s[24:27], s61 offen offset:1024  lds
    buffer_load_dwordx4 v22, s[24:27], s61 offen offset:2048  lds
    buffer_load_dwordx4 v23, s[24:27], s61 offen offset:3072  lds
    v_add_u32 v30, 16384, v24
    ds_write_b128 v30, v[48:51] offset:0
    ds_write_b128 v30, v[52:55] offset:1024
    ds_write_b128 v30, v[56:59] offset:2048
    ds_write_b128 v30, v[60:63] offset:3072
    s_waitcnt vmcnt(16)
    s_waitcnt lgkmcnt(0)
    s_barrier
    s_add_u32 s61, s85, 0
    s_add_u32 m0, s66, 131072
    s_nop 0
    buffer_load_dwordx4 v20, s[24:27], s61 offen offset:0  lds
    buffer_load_dwordx4 v21, s[24:27], s61 offen offset:1024  lds
    buffer_load_dwordx4 v22, s[24:27], s61 offen offset:2048  lds
    buffer_load_dwordx4 v23, s[24:27], s61 offen offset:3072  lds
    s_add_u32 s61, s85, 256
    s_add_u32 m0, s66, 147456
    s_nop 0
    buffer_load_dwordx4 v20, s[24:27], s61 offen offset:0  lds
    buffer_load_dwordx4 v21, s[24:27], s61 offen offset:1024  lds
    buffer_load_dwordx4 v22, s[24:27], s61 offen offset:2048  lds
    buffer_load_dwordx4 v23, s[24:27], s61 offen offset:3072  lds
    s_add_u32 s61, s81, 0
    s_add_u32 m0, s66, 114688
    s_nop 0
    buffer_load_dwordx4 v24, s[32:35], s61 offen offset:0 sc1 lds
    buffer_load_dwordx4 v24, s[32:35], s61 offen offset:1024 sc1 lds
    buffer_load_dwordx4 v24, s[32:35], s61 offen offset:2048 sc1 lds
    buffer_load_dwordx4 v24, s[32:35], s61 offen offset:3072 sc1 lds
    s_waitcnt vmcnt(12)
    s_and_b32 s64, s60, -4
    s_lshl_b32 s64, s64, 10
    s_lshl_b32 s3, s71, 4
    s_add_u32 s64, s64, s3
    s_lshl_b32 s3, s46, 2
    s_add_u32 s64, s64, s3
    s_add_u32 s64, s64, 31457408
    s_mov_b64 exec, 15
    buffer_store_dword v29, v28, s[32:35], s64 offen sc1
    s_mov_b64 exec, -1
    s_barrier
    s_add_u32 s61, s85, 131072
    s_add_u32 m0, s66, 81920
    s_nop 0
    buffer_load_dwordx4 v20, s[24:27], s61 offen offset:0  lds
    buffer_load_dwordx4 v21, s[24:27], s61 offen offset:1024  lds
    buffer_load_dwordx4 v22, s[24:27], s61 offen offset:2048  lds
    buffer_load_dwordx4 v23, s[24:27], s61 offen offset:3072  lds
    s_add_u32 s61, s85, 131328
    s_add_u32 m0, s66, 98304
    s_nop 0
    buffer_load_dwordx4 v20, s[24:27], s61 offen offset:0  lds
    buffer_load_dwordx4 v21, s[24:27], s61 offen offset:1024  lds
    buffer_load_dwordx4 v22, s[24:27], s61 offen offset:2048  lds
    buffer_load_dwordx4 v23, s[24:27], s61 offen offset:3072  lds
    s_add_u32 s61, s81, 16384
    s_add_u32 m0, s66, 65536
    s_nop 0
    buffer_load_dwordx4 v24, s[32:35], s61 offen offset:0 sc1 lds
    buffer_load_dwordx4 v24, s[32:35], s61 offen offset:1024 sc1 lds
    buffer_load_dwordx4 v24, s[32:35], s61 offen offset:2048 sc1 lds
    buffer_load_dwordx4 v24, s[32:35], s61 offen offset:3072 sc1 lds
    s_waitcnt vmcnt(13)
    s_barrier
    s_add_u32 s61, s86, 0
    s_add_u32 m0, s66, 32768
    s_nop 0
    buffer_load_dwordx4 v20, s[24:27], s61 offen offset:0  lds
    buffer_load_dwordx4 v21, s[24:27], s61 offen offset:1024  lds
    buffer_load_dwordx4 v22, s[24:27], s61 offen offset:2048  lds
    buffer_load_dwordx4 v23, s[24:27], s61 offen offset:3072  lds
    s_add_u32 s61, s86, 256
    s_add_u32 m0, s66, 49152
    s_nop 0
    buffer_load_dwordx4 v20, s[24:27], s61 offen offset:0  lds
    buffer_load_dwordx4 v21, s[24:27], s61 offen offset:1024  lds
    buffer_load_dwordx4 v22, s[24:27], s61 offen offset:2048  lds
    buffer_load_dwordx4 v23, s[24:27], s61 offen offset:3072  lds
    s_add_u32 s61, s82, 0
    s_add_u32 m0, s66, 16384
    s_nop 0
    buffer_load_dwordx4 v24, s[32:35], s61 offen offset:0 sc1 lds
    buffer_load_dwordx4 v24, s[32:35], s61 offen offset:1024 sc1 lds
    buffer_load_dwordx4 v24, s[32:35], s61 offen offset:2048 sc1 lds
    buffer_load_dwordx4 v24, s[32:35], s61 offen offset:3072 sc1 lds
    s_waitcnt vmcnt(12)
    s_barrier
    s_add_u32 s61, s86, 131072
    s_add_u32 m0, s66, 131072
    s_nop 0
    buffer_load_dwordx4 v20, s[24:27], s61 offen offset:0  lds
    buffer_load_dwordx4 v21, s[24:27], s61 offen offset:1024  lds
    buffer_load_dwordx4 v22, s[24:27], s61 offen offset:2048  lds
    buffer_load_dwordx4 v23, s[24:27], s61 offen offset:3072  lds
    s_add_u32 s61, s86, 131328
    s_add_u32 m0, s66, 147456
    s_nop 0
    buffer_load_dwordx4 v20, s[24:27], s61 offen offset:0  lds
    buffer_load_dwordx4 v21, s[24:27], s61 offen offset:1024  lds
    buffer_load_dwordx4 v22, s[24:27], s61 offen offset:2048  lds
    buffer_load_dwordx4 v23, s[24:27], s61 offen offset:3072  lds
    s_add_u32 s61, s82, 16384
    s_add_u32 m0, s66, 114688
    s_nop 0
    buffer_load_dwordx4 v24, s[32:35], s61 offen offset:0 sc1 lds
    buffer_load_dwordx4 v24, s[32:35], s61 offen offset:1024 sc1 lds
    buffer_load_dwordx4 v24, s[32:35], s61 offen offset:2048 sc1 lds
    buffer_load_dwordx4 v24, s[32:35], s61 offen offset:3072 sc1 lds
    s_waitcnt vmcnt(12)
    s_barrier
    buffer_load_dword v25, v27, s[32:35], s74 offen offset:128 sc1
    s_add_u32 s61, s87, 0
    s_add_u32 m0, s66, 81920
    s_nop 0
    buffer_load_dwordx4 v20, s[24:27], s61 offen offset:0  lds
    buffer_load_dwordx4 v21, s[24:27], s61 offen offset:1024  lds
    buffer_load_dwordx4 v22, s[24:27], s61 offen offset:2048  lds
    buffer_load_dwordx4 v23, s[24:27], s61 offen offset:3072  lds
    s_add_u32 s61, s87, 256
    s_add_u32 m0, s66, 98304
    s_nop 0
    buffer_load_dwordx4 v20, s[24:27], s61 offen offset:0  lds
    buffer_load_dwordx4 v21, s[24:27], s61 offen offset:1024  lds
    buffer_load_dwordx4 v22, s[24:27], s61 offen offset:2048  lds
    buffer_load_dwordx4 v23, s[24:27], s61 offen offset:3072  lds
    s_add_u32 s61, s83, 0
    s_add_u32 m0, s66, 65536
    s_nop 0
    buffer_load_dwordx4 v24, s[32:35], s61 offen offset:0 sc1 lds
    buffer_load_dwordx4 v24, s[32:35], s61 offen offset:1024 sc1 lds
    buffer_load_dwordx4 v24, s[32:35], s61 offen offset:2048 sc1 lds
    buffer_load_dwordx4 v24, s[32:35], s61 offen offset:3072 sc1 lds
    s_waitcnt vmcnt(13)
    s_barrier
    s_add_u32 s61, s87, 131072
    s_add_u32 m0, s66, 32768
    s_nop 0
    buffer_load_dwordx4 v20, s[24:27], s61 offen offset:0  lds
    buffer_load_dwordx4 v21, s[24:27], s61 offen offset:1024  lds
    buffer_load_dwordx4 v22, s[24:27], s61 offen offset:2048  lds
    buffer_load_dwordx4 v23, s[24:27], s61 offen offset:3072  lds
    s_add_u32 s61, s87, 131328
    s_add_u32 m0, s66, 49152
    s_nop 0
    buffer_load_dwordx4 v20, s[24:27], s61 offen offset:0  lds
    buffer_load_dwordx4 v21, s[24:27], s61 offen offset:1024  lds
    buffer_load_dwordx4 v22, s[24:27], s61 offen offset:2048  lds
    buffer_load_dwordx4 v23, s[24:27], s61 offen offset:3072  lds
    s_add_u32 s61, s83, 16384
    s_add_u32 m0, s66, 16384
    s_nop 0
    buffer_load_dwordx4 v24, s[32:35], s61 offen offset:0 sc1 lds
    buffer_load_dwordx4 v24, s[32:35], s61 offen offset:1024 sc1 lds
    buffer_load_dwordx4 v24, s[32:35], s61 offen offset:2048 sc1 lds
    buffer_load_dwordx4 v24, s[32:35], s61 offen offset:3072 sc1 lds
    s_waitcnt vmcnt(12)
    s_mov_b32 s72, 0
L_ps_7:
    v_cmp_ne_u32 vcc, 1, v25
    s_cbranch_vccz L_pd_6
    s_sleep 4
    buffer_load_dword v25, v27, s[32:35], s74 offen offset:128 sc1
    s_add_u32 s72, s72, 1
    s_waitcnt vmcnt(0)
    s_cmp_lt_u32 s72, 0x40000
    s_cbranch_scc1 L_ps_7
L_pd_6:
    s_barrier
    s_add_u32 s61, s85, 262144
    s_add_u32 m0, s66, 131072
    s_nop 0
    buffer_load_dwordx4 v20, s[24:27], s61 offen offset:0  lds
    buffer_load_dwordx4 v21, s[24:27], s61 offen offset:1024  lds
    buffer_load_dwordx4 v22, s[24:27], s61 offen offset:2048  lds
    buffer_load_dwordx4 v23, s[24:27], s61 offen offset:3072  lds
    s_add_u32 s61, s85, 262400
    s_add_u32 m0, s66, 147456
    s_nop 0
    buffer_load_dwordx4 v20, s[24:27], s61 offen offset:0  lds
    buffer_load_dwordx4 v21, s[24:27], s61 offen offset:1024  lds
    buffer_load_dwordx4 v22, s[24:27], s61 offen offset:2048  lds
    buffer_load_dwordx4 v23, s[24:27], s61 offen offset:3072  lds
    s_add_u32 s61, s81, 32768
    s_add_u32 m0, s66, 114688
    s_nop 0
    buffer_load_dwordx4 v24, s[32:35], s61 offen offset:0 sc1 lds
    buffer_load_dwordx4 v24, s[32:35], s61 offen offset:1024 sc1 lds
    buffer_load_dwordx4 v24, s[32:35], s61 offen offset:2048 sc1 lds
    buffer_load_dwordx4 v24, s[32:35], s61 offen offset:3072 sc1 lds
    s_waitcnt vmcnt(12)
    s_barrier
    s_add_u32 s61, s85, 393216
    s_add_u32 m0, s66, 81920
    s_nop 0
    buffer_load_dwordx4 v20, s[24:27], s61 offen offset:0  lds
    buffer_load_dwordx4 v21, s[24:27], s61 offen offset:1024  lds
    buffer_load_dwordx4 v22, s[24:27], s61 offen offset:2048  lds
    buffer_load_dwordx4 v23, s[24:27], s61 offen offset:3072  lds
    s_add_u32 s61, s85, 393472
    s_add_u32 m0, s66, 98304
    s_nop 0
    buffer_load_dwordx4 v20, s[24:27], s61 offen offset:0  lds
    buffer_load_dwordx4 v21, s[24:27], s61 offen offset:1024  lds
    buffer_load_dwordx4 v22, s[24:27], s61 offen offset:2048  lds
    buffer_load_dwordx4 v23, s[24:27], s61 offen offset:3072  lds
    s_add_u32 s61, s81, 49152
    s_add_u32 m0, s66, 65536
    s_nop 0
    buffer_load_dwordx4 v24, s[32:35], s61 offen offset:0 sc1 lds
    buffer_load_dwordx4 v24, s[32:35], s61 offen offset:1024 sc1 lds
    buffer_load_dwordx4 v24, s[32:35], s61 offen offset:2048 sc1 lds
    buffer_load_dwordx4 v24, s[32:35], s61 offen offset:3072 sc1 lds
    s_waitcnt vmcnt(12)
    s_barrier
    s_add_u32 s61, s86, 262144
    s_add_u32 m0, s66, 32768
    s_nop 0
    buffer_load_dwordx4 v20, s[24:27], s61 offen offset:0  lds
    buffer_load_dwordx4 v21, s[24:27], s61 offen offset:1024  lds
    buffer_load_dwordx4 v22, s[24:27], s61 offen offset:2048  lds
    buffer_load_dwordx4 v23, s[24:27], s61 offen offset:3072  lds
    s_add_u32 s61, s86, 262400
    s_add_u32 m0, s66, 49152
    s_nop 0
    buffer_load_dwordx4 v20, s[24:27], s61 offen offset:0  lds
    buffer_load_dwordx4 v21, s[24:27], s61 offen offset:1024  lds
    buffer_load_dwordx4 v22, s[24:27], s61 offen offset:2048  lds
    buffer_load_dwordx4 v23, s[24:27], s61 offen offset:3072  lds
    s_add_u32 s61, s82, 32768
    s_add_u32 m0, s66, 16384
    s_nop 0
    buffer_load_dwordx4 v24, s[32:35], s61 offen offset:0 sc1 lds
    buffer_load_dwordx4 v24, s[32:35], s61 offen offset:1024 sc1 lds
    buffer_load_dwordx4 v24, s[32:35], s61 offen offset:2048 sc1 lds
    buffer_load_dwordx4 v24, s[32:35], s61 offen offset:3072 sc1 lds
    s_waitcnt vmcnt(12)
    s_barrier
    s_add_u32 s61, s86, 393216
    s_add_u32 m0, s66, 131072
    s_nop 0
    buffer_load_dwordx4 v20, s[24:27], s61 offen offset:0  lds
    buffer_load_dwordx4 v21, s[24:27], s61 offen offset:1024  lds
    buffer_load_dwordx4 v22, s[24:27], s61 offen offset:2048  lds
    buffer_load_dwordx4 v23, s[24:27], s61 offen offset:3072  lds
    s_add_u32 s61, s86, 393472
    s_add_u32 m0, s66, 147456
    s_nop 0
    buffer_load_dwordx4 v20, s[24:27], s61 offen offset:0  lds
    buffer_load_dwordx4 v21, s[24:27], s61 offen offset:1024  lds
    buffer_load_dwordx4 v22, s[24:27], s61 offen offset:2048  lds
    buffer_load_dwordx4 v23, s[24:27], s61 offen offset:3072  lds
    s_add_u32 s61, s82, 49152
    s_add_u32 m0, s66, 114688
    s_nop 0
    buffer_load_dwordx4 v24, s[32:35], s61 offen offset:0 sc1 lds
    buffer_load_dwordx4 v24, s[32:35], s61 offen offset:1024 sc1 lds
    buffer_load_dwordx4 v24, s[32:35], s61 offen offset:2048 sc1 lds
    buffer_load_dwordx4 v24, s[32:35], s61 offen offset:3072 sc1 lds
    s_waitcnt vmcnt(12)
    s_barrier
    s_add_u32 s61, s87, 262144
    s_add_u32 m0, s66, 81920
    s_nop 0
    buffer_load_dwordx4 v20, s[24:27], s61 offen offset:0  lds
    buffer_load_dwordx4 v21, s[24:27], s61 offen offset:1024  lds
    buffer_load_dwordx4 v22, s[24:27], s61 offen offset:2048  lds
    buffer_load_dwordx4 v23, s[24:27], s61 offen offset:3072  lds
    s_add_u32 s61, s87, 262400
    s_add_u32 m0, s66, 98304
    s_nop 0
    buffer_load_dwordx4 v20, s[24:27], s61 offen offset:0  lds
    buffer_load_dwordx4 v21, s[24:27], s61 offen offset:1024  lds
    buffer_load_dwordx4 v22, s[24:27], s61 offen offset:2048  lds
    buffer_load_dwordx4 v23, s[24:27], s61 offen offset:3072  lds
    s_add_u32 s61, s83, 32768
    s_add_u32 m0, s66, 65536
    s_nop 0
    buffer_load_dwordx4 v24, s[32:35], s61 offen offset:0 sc1 lds
    buffer_load_dwordx4 v24, s[32:35], s61 offen offset:1024 sc1 lds
    buffer_load_dwordx4 v24, s[32:35], s61 offen offset:2048 sc1 lds
    buffer_load_dwordx4 v24, s[32:35], s61 offen offset:3072 sc1 lds
    s_waitcnt vmcnt(12)
    s_barrier
    s_add_u32 s61, s87, 393216
    s_add_u32 m0, s66, 32768
    s_nop 0
    buffer_load_dwordx4 v20, s[24:27], s61 offen offset:0  lds
    buffer_load_dwordx4 v21, s[24:27], s61 offen offset:1024  lds
    buffer_load_dwordx4 v22, s[24:27], s61 offen offset:2048  lds
    buffer_load_dwordx4 v23, s[24:27], s61 offen offset:3072  lds
    s_add_u32 s61, s87, 393472
    s_add_u32 m0, s66, 49152
    s_nop 0
    buffer_load_dwordx4 v20, s[24:27], s61 offen offset:0  lds
    buffer_load_dwordx4 v21, s[24:27], s61 offen offset:1024  lds
    buffer_load_dwordx4 v22, s[24:27], s61 offen offset:2048  lds
    buffer_load_dwordx4 v23, s[24:27], s61 offen offset:3072  lds
    s_add_u32 s61, s83, 49152
    s_add_u32 m0, s66, 16384
    s_nop 0
    buffer_load_dwordx4 v24, s[32:35], s61 offen offset:0 sc1 lds
    buffer_load_dwordx4 v24, s[32:35], s61 offen offset:1024 sc1 lds
    buffer_load_dwordx4 v24, s[32:35], s61 offen offset:2048 sc1 lds
    buffer_load_dwordx4 v24, s[32:35], s61 offen offset:3072 sc1 lds
    s_waitcnt vmcnt(12)
    s_barrier
    s_waitcnt vmcnt(0)
    s_barrier
    s_endpgm
L_end:
    s_endpgm
L_compute:
    s_load_dwordx2 s[12:13], s[4:5], 8
    s_load_dwordx2 s[16:17], s[4:5], 16
    s_load_dwordx2 s[24:25], s[4:5], 32
    s_load_dwordx2 s[28:29], s[0:1], 80
    s_load_dwordx2 s[36:37], s[0:1], 88
    s_load_dwordx2 s[32:33], s[0:1], 96
    s_and_b32 s40, s2, 7
    s_lshr_b32 s41, s2, 3
    s_mov_b32 s14, 33554432
    s_mov_b32 s15, 0x00020000
    s_mov_b32 s18, 33554432
    s_mov_b32 s19, 0x00020000
    s_mov_b32 s26, 8388608
    s_mov_b32 s27, 0x00020000
    s_mov_b32 s30, 4194304
    s_mov_b32 s31, 0x00020000
    s_mov_b32 s34, 67108864
    s_mov_b32 s35, 0x00020000
    s_mov_b32 s38, 256
    s_mov_b32 s39, 0x00020000
    s_and_b32 s71, s48, 3
    s_lshl_b32 s3, s42, 3
    s_add_u32 s64, s3, s44
    s_lshl_b32 s59, s64, 4
    s_lshl_b32 s3, s43, 2
    s_add_u32 s3, s3, s71
    s_add_u32 s60, s3, s59
    s_lshl_b32 s70, s64, 20
    s_and_b32 s49, s46, 1
    s_lshr_b32 s50, s46, 1
    v_lshrrev_b32 v16, 4, v0
    v_and_b32 v17, 15, v0
    v_bfe_u32 v18, v0, 2, 2
    v_lshlrev_b32 v19, 3, v16
    v_add_u32 v19, v19, v18
    v_lshlrev_b32 v19, 8, v19
    v_lshl_add_u32 v19, v18, 6, v19
    v_and_b32 v20, 1, v16
    v_lshl_add_u32 v19, v20, 5, v19
    v_and_b32 v21, 3, v0
    v_lshl_add_u32 v1, v21, 3, v19
    v_lshrrev_b32 v21, 1, v16
    v_lshl_add_u32 v21, v20, 1, v21
    v_lshl_add_u32 v21, v21, 4, v17
    v_lshlrev_b32 v2, 4, v21
    v_lshlrev_b32 v3, 4, v0
    v_lshrrev_b32 v19, 1, v17
    v_xor_b32 v19, v19, v16
    v_lshlrev_b32 v19, 4, v19
    v_lshl_add_u32 v19, v17, 7, v19
    s_lshl_b32 s3, s49, 13
    s_add_u32 s3, s3, 16384
    v_add_u32 v4, s3, v19
    v_xor_b32 v5, 64, v4
    s_lshl_b32 s3, s50, 14
    s_add_u32 s3, s3, 32768
    v_add_u32 v6, s3, v1
    v_xor_b32 v7, 32, v6
    v_xor_b32 v8, 64, v6
    v_xor_b32 v9, 96, v6
    v_xor_b32 v10, 128, v6
    v_xor_b32 v11, 160, v6
    v_xor_b32 v12, 192, v6
    v_xor_b32 v13, 224, v6
    s_mov_b32 s56, 0
    s_mov_b32 s57, 16
    s_mov_b32 s52, 0
    s_mov_b32 s54, 49152
    s_mov_b32 s55, -98304
    s_waitcnt lgkmcnt(0)
    s_and_b32 s3, s44, 3
    s_mul_i32 s3, s3, 5
    s_add_u32 s3, s3, s59
    s_cmp_lg_u32 s3, s60
    s_cbranch_scc1 L_gemm
    v_mov_b32 v16, 0
    v_mov_b32 v17, 0
    v_mov_b32 v18, 0
    v_mov_b32 v19, 0
    s_lshl_b32 s3, s59, 10
    s_lshl_b32 s61, s46, 12
    s_add_u32 s3, s3, s61
    s_add_u32 s3, s3, 31457280
    buffer_store_dwordx4 v[16:19], v3, s[32:35], s3 offen offset:0 sc1
    buffer_store_dwordx4 v[16:19], v3, s[32:35], s3 offen offset:1024 sc1
    buffer_store_dwordx4 v[16:19], v3, s[32:35], s3 offen offset:2048 sc1
    buffer_store_dwordx4 v[16:19], v3, s[32:35], s3 offen offset:3072 sc1
L_gemm:
    s_mov_b32 s51, 0
    s_barrier
    ds_read_b128 v[16:19], v4 offset:0
    ds_read_b64_tr_b16 v[48:49], v6 offset:0
    ds_read_b64_tr_b16 v[50:51], v6 offset:1024
    ds_read_b128 v[20:23], v4 offset:2048
    ds_read_b128 v[24:27], v4 offset:4096
    ds_read_b128 v[28:31], v4 offset:6144
    ds_read_b64_tr_b16 v[52:53], v7 offset:0
    ds_read_b64_tr_b16 v[54:55], v7 offset:1024
    ds_read_b64_tr_b16 v[56:57], v8 offset:0
    ds_read_b64_tr_b16 v[58:59], v8 offset:1024
    ds_read_b64_tr_b16 v[60:61], v9 offset:0
    ds_read_b64_tr_b16 v[62:63], v9 offset:1024
    ds_read_b64_tr_b16 v[64:65], v10 offset:0
    ds_read_b64_tr_b16 v[66:67], v10 offset:1024
    s_waitcnt lgkmcnt(0)
    ds_read_b64_tr_b16 v[68:69], v11 offset:0
    ds_read_b64_tr_b16 v[70:71], v11 offset:1024
    ds_read_b64_tr_b16 v[72:73], v12 offset:0
    ds_read_b64_tr_b16 v[74:75], v12 offset:1024
    ds_read_b64_tr_b16 v[76:77], v13 offset:0
    ds_read_b64_tr_b16 v[78:79], v13 offset:1024
    v_mfma_f32_16x16x32_bf16 v[128:131], v[48:51], v[16:19], 0
    s_add_u32 s52, s52, 1
    v_mfma_f32_16x16x32_bf16 v[132:135], v[48:51], v[20:23], 0
    s_cmp_eq_u32 s52, 3
    v_mfma_f32_16x16x32_bf16 v[136:139], v[48:51], v[24:27], 0
    s_cselect_b32 s53, s55, s54
    v_mfma_f32_16x16x32_bf16 v[140:143], v[48:51], v[28:31], 0
    s_cselect_b32 s52, 0, s52
    v_mfma_f32_16x16x32_bf16 v[144:147], v[52:55], v[16:19], 0
    s_add_u32 s51, s51, 1
    v_mfma_f32_16x16x32_bf16 v[148:151], v[52:55], v[20:23], 0
    s_waitcnt lgkmcnt(0)
    ds_read_b128 v[32:35], v5 offset:0
    v_add_u32 v4, s53, v4
    v_mfma_f32_16x16x32_bf16 v[152:155], v[52:55], v[24:27], 0
    ds_read_b64_tr_b16 v[80:81], v6 offset:8192
    v_mfma_f32_16x16x32_bf16 v[156:159], v[52:55], v[28:31], 0
    ds_read_b64_tr_b16 v[82:83], v6 offset:9216
    v_mfma_f32_16x16x32_bf16 v[160:163], v[56:59], v[16:19], 0
    ds_read_b128 v[36:39], v5 offset:2048
    v_add_u32 v6, s53, v6
    v_mfma_f32_16x16x32_bf16 v[164:167], v[56:59], v[20:23], 0
    ds_read_b128 v[40:43], v5 offset:4096
    v_mfma_f32_16x16x32_bf16 v[168:171], v[56:59], v[24:27], 0
    ds_read_b128 v[44:47], v5 offset:6144
    v_mfma_f32_16x16x32_bf16 v[172:175], v[56:59], v[28:31], 0
    ds_read_b64_tr_b16 v[84:85], v7 offset:8192
    v_add_u32 v5, s53, v5
    v_mfma_f32_16x16x32_bf16 v[176:179], v[60:63], v[16:19], 0
    ds_read_b64_tr_b16 v[86:87], v7 offset:9216
    v_mfma_f32_16x16x32_bf16 v[180:183], v[60:63], v[20:23], 0
    ds_read_b64_tr_b16 v[88:89], v8 offset:8192
    v_add_u32 v7, s53, v7
    v_mfma_f32_16x16x32_bf16 v[184:187], v[60:63], v[24:27], 0
    ds_read_b64_tr_b16 v[90:91], v8 offset:9216
    v_mfma_f32_16x16x32_bf16 v[188:191], v[60:63], v[28:31], 0
    ds_read_b64_tr_b16 v[92:93], v9 offset:8192
    v_add_u32 v8, s53, v8
    v_mfma_f32_16x16x32_bf16 v[192:195], v[64:67], v[16:19], 0
    ds_read_b64_tr_b16 v[94:95], v9 offset:9216
    v_mfma_f32_16x16x32_bf16 v[196:199], v[64:67], v[20:23], 0
    ds_read_b64_tr_b16 v[96:97], v10 offset:8192
    v_add_u32 v9, s53, v9
    v_mfma_f32_16x16x32_bf16 v[200:203], v[64:67], v[24:27], 0
    ds_read_b64_tr_b16 v[98:99], v10 offset:9216
    v_mfma_f32_16x16x32_bf16 v[204:207], v[64:67], v[28:31], 0
    ds_read_b64_tr_b16 v[100:101], v11 offset:8192
    v_add_u32 v10, s53, v10
    v_mfma_f32_16x16x32_bf16 v[208:211], v[68:71], v[16:19], 0
    ds_read_b64_tr_b16 v[102:103], v11 offset:9216
    v_mfma_f32_16x16x32_bf16 v[212:215], v[68:71], v[20:23], 0
    ds_read_b64_tr_b16 v[104:105], v12 offset:8192
    v_add_u32 v11, s53, v11
    v_mfma_f32_16x16x32_bf16 v[216:219], v[68:71], v[24:27], 0
    ds_read_b64_tr_b16 v[106:107], v12 offset:9216
    v_mfma_f32_16x16x32_bf16 v[220:223], v[68:71], v[28:31], 0
    ds_read_b64_tr_b16 v[108:109], v13 offset:8192
    v_add_u32 v12, s53, v12
    v_mfma_f32_16x16x32_bf16 v[224:227], v[72:75], v[16:19], 0
    ds_read_b64_tr_b16 v[110:111], v13 offset:9216
    v_mfma_f32_16x16x32_bf16 v[228:231], v[72:75], v[20:23], 0
    v_add_u32 v13, s53, v13
    v_mfma_f32_16x16x32_bf16 v[232:235], v[72:75], v[24:27], 0
    v_mfma_f32_16x16x32_bf16 v[236:239], v[72:75], v[28:31], 0
    v_mfma_f32_16x16x32_bf16 v[240:243], v[76:79], v[16:19], 0
    v_mfma_f32_16x16x32_bf16 v[244:247], v[76:79], v[20:23], 0
    v_mfma_f32_16x16x32_bf16 v[248:251], v[76:79], v[24:27], 0
    v_mfma_f32_16x16x32_bf16 v[252:255], v[76:79], v[28:31], 0
    s_waitcnt lgkmcnt(0)
    s_waitcnt vmcnt(0)
    s_branch L_gmid
    .p2align 3
L_gloop:
    v_mfma_f32_16x16x32_bf16 v[128:131], v[48:51], v[16:19], v[128:131]
    s_add_u32 s52, s52, 1
    v_mfma_f32_16x16x32_bf16 v[132:135], v[48:51], v[20:23], v[132:135]
    s_cmp_eq_u32 s52, 3
    v_mfma_f32_16x16x32_bf16 v[136:139], v[48:51], v[24:27], v[136:139]
    s_cselect_b32 s53, s55, s54
    v_mfma_f32_16x16x32_bf16 v[140:143], v[48:51], v[28:31], v[140:143]
    s_cselect_b32 s52, 0, s52
    v_mfma_f32_16x16x32_bf16 v[144:147], v[52:55], v[16:19], v[144:147]
    s_add_u32 s51, s51, 1
    v_mfma_f32_16x16x32_bf16 v[148:151], v[52:55], v[20:23], v[148:151]
    s_waitcnt lgkmcnt(0)
    ds_read_b128 v[32:35], v5 offset:0
    v_add_u32 v4, s53, v4
    v_mfma_f32_16x16x32_bf16 v[152:155], v[52:55], v[24:27], v[152:155]
    ds_read_b64_tr_b16 v[80:81], v6 offset:8192
    v_mfma_f32_16x16x32_bf16 v[156:159], v[52:55], v[28:31], v[156:159]
    ds_read_b64_tr_b16 v[82:83], v6 offset:9216
    v_mfma_f32_16x16x32_bf16 v[160:163], v[56:59], v[16:19], v[160:163]
    ds_read_b128 v[36:39], v5 offset:2048
    v_add_u32 v6, s53, v6
    v_mfma_f32_16x16x32_bf16 v[164:167], v[56:59], v[20:23], v[164:167]
    ds_read_b128 v[40:43], v5 offset:4096
    v_mfma_f32_16x16x32_bf16 v[168:171], v[56:59], v[24:27], v[168:171]
    ds_read_b128 v[44:47], v5 offset:6144
    v_mfma_f32_16x16x32_bf16 v[172:175], v[56:59], v[28:31], v[172:175]
    ds_read_b64_tr_b16 v[84:85], v7 offset:8192
    v_add_u32 v5, s53, v5
    v_mfma_f32_16x16x32_bf16 v[176:179], v[60:63], v[16:19], v[176:179]
    ds_read_b64_tr_b16 v[86:87], v7 offset:9216
    v_mfma_f32_16x16x32_bf16 v[180:183], v[60:63], v[20:23], v[180:183]
    ds_read_b64_tr_b16 v[88:89], v8 offset:8192
    v_add_u32 v7, s53, v7
    v_mfma_f32_16x16x32_bf16 v[184:187], v[60:63], v[24:27], v[184:187]
    ds_read_b64_tr_b16 v[90:91], v8 offset:9216
    v_mfma_f32_16x16x32_bf16 v[188:191], v[60:63], v[28:31], v[188:191]
    ds_read_b64_tr_b16 v[92:93], v9 offset:8192
    v_add_u32 v8, s53, v8
    v_mfma_f32_16x16x32_bf16 v[192:195], v[64:67], v[16:19], v[192:195]
    ds_read_b64_tr_b16 v[94:95], v9 offset:9216
    v_mfma_f32_16x16x32_bf16 v[196:199], v[64:67], v[20:23], v[196:199]
    ds_read_b64_tr_b16 v[96:97], v10 offset:8192
    v_add_u32 v9, s53, v9
    v_mfma_f32_16x16x32_bf16 v[200:203], v[64:67], v[24:27], v[200:203]
    ds_read_b64_tr_b16 v[98:99], v10 offset:9216
    v_mfma_f32_16x16x32_bf16 v[204:207], v[64:67], v[28:31], v[204:207]
    ds_read_b64_tr_b16 v[100:101], v11 offset:8192
    v_add_u32 v10, s53, v10
    v_mfma_f32_16x16x32_bf16 v[208:211], v[68:71], v[16:19], v[208:211]
    ds_read_b64_tr_b16 v[102:103], v11 offset:9216
    v_mfma_f32_16x16x32_bf16 v[212:215], v[68:71], v[20:23], v[212:215]
    ds_read_b64_tr_b16 v[104:105], v12 offset:8192
    v_add_u32 v11, s53, v11
    v_mfma_f32_16x16x32_bf16 v[216:219], v[68:71], v[24:27], v[216:219]
    ds_read_b64_tr_b16 v[106:107], v12 offset:9216
    v_mfma_f32_16x16x32_bf16 v[220:223], v[68:71], v[28:31], v[220:223]
    ds_read_b64_tr_b16 v[108:109], v13 offset:8192
    v_add_u32 v12, s53, v12
    v_mfma_f32_16x16x32_bf16 v[224:227], v[72:75], v[16:19], v[224:227]
    ds_read_b64_tr_b16 v[110:111], v13 offset:9216
    v_mfma_f32_16x16x32_bf16 v[228:231], v[72:75], v[20:23], v[228:231]
    v_add_u32 v13, s53, v13
    v_mfma_f32_16x16x32_bf16 v[232:235], v[72:75], v[24:27], v[232:235]
    v_mfma_f32_16x16x32_bf16 v[236:239], v[72:75], v[28:31], v[236:239]
    v_mfma_f32_16x16x32_bf16 v[240:243], v[76:79], v[16:19], v[240:243]
    v_mfma_f32_16x16x32_bf16 v[244:247], v[76:79], v[20:23], v[244:247]
    v_mfma_f32_16x16x32_bf16 v[248:251], v[76:79], v[24:27], v[248:251]
    v_mfma_f32_16x16x32_bf16 v[252:255], v[76:79], v[28:31], v[252:255]
    s_waitcnt lgkmcnt(0)
L_gmid:
    v_mfma_f32_16x16x32_bf16 v[128:131], v[80:83], v[32:35], v[128:131]
    s_barrier
    v_mfma_f32_16x16x32_bf16 v[132:135], v[80:83], v[36:39], v[132:135]
    ds_read_b128 v[16:19], v4 offset:0
    v_mfma_f32_16x16x32_bf16 v[136:139], v[80:83], v[40:43], v[136:139]
    ds_read_b64_tr_b16 v[48:49], v6 offset:0
    v_mfma_f32_16x16x32_bf16 v[140:143], v[80:83], v[44:47], v[140:143]
    ds_read_b64_tr_b16 v[50:51], v6 offset:1024
    v_mfma_f32_16x16x32_bf16 v[144:147], v[84:87], v[32:35], v[144:147]
    ds_read_b128 v[20:23], v4 offset:2048
    v_mfma_f32_16x16x32_bf16 v[148:151], v[84:87], v[36:39], v[148:151]
    ds_read_b128 v[24:27], v4 offset:4096
    v_mfma_f32_16x16x32_bf16 v[152:155], v[84:87], v[40:43], v[152:155]
    ds_read_b128 v[28:31], v4 offset:6144
    v_mfma_f32_16x16x32_bf16 v[156:159], v[84:87], v[44:47], v[156:159]
    ds_read_b64_tr_b16 v[52:53], v7 offset:0
    v_mfma_f32_16x16x32_bf16 v[160:163], v[88:91], v[32:35], v[160:163]
    ds_read_b64_tr_b16 v[54:55], v7 offset:1024
    v_mfma_f32_16x16x32_bf16 v[164:167], v[88:91], v[36:39], v[164:167]
    ds_read_b64_tr_b16 v[56:57], v8 offset:0
    v_mfma_f32_16x16x32_bf16 v[168:171], v[88:91], v[40:43], v[168:171]
    ds_read_b64_tr_b16 v[58:59], v8 offset:1024
    v_mfma_f32_16x16x32_bf16 v[172:175], v[88:91], v[44:47], v[172:175]
    ds_read_b64_tr_b16 v[60:61], v9 offset:0
    v_mfma_f32_16x16x32_bf16 v[176:179], v[92:95], v[32:35], v[176:179]
    ds_read_b64_tr_b16 v[62:63], v9 offset:1024
    v_mfma_f32_16x16x32_bf16 v[180:183], v[92:95], v[36:39], v[180:183]
    ds_read_b64_tr_b16 v[64:65], v10 offset:0
    v_mfma_f32_16x16x32_bf16 v[184:187], v[92:95], v[40:43], v[184:187]
    ds_read_b64_tr_b16 v[66:67], v10 offset:1024
    v_mfma_f32_16x16x32_bf16 v[188:191], v[92:95], v[44:47], v[188:191]
    ds_read_b64_tr_b16 v[68:69], v11 offset:0
    v_mfma_f32_16x16x32_bf16 v[192:195], v[96:99], v[32:35], v[192:195]
    ds_read_b64_tr_b16 v[70:71], v11 offset:1024
    v_mfma_f32_16x16x32_bf16 v[196:199], v[96:99], v[36:39], v[196:199]
    ds_read_b64_tr_b16 v[72:73], v12 offset:0
    v_mfma_f32_16x16x32_bf16 v[200:203], v[96:99], v[40:43], v[200:203]
    ds_read_b64_tr_b16 v[74:75], v12 offset:1024
    v_mfma_f32_16x16x32_bf16 v[204:207], v[96:99], v[44:47], v[204:207]
    ds_read_b64_tr_b16 v[76:77], v13 offset:0
    v_mfma_f32_16x16x32_bf16 v[208:211], v[100:103], v[32:35], v[208:211]
    ds_read_b64_tr_b16 v[78:79], v13 offset:1024
    v_mfma_f32_16x16x32_bf16 v[212:215], v[100:103], v[36:39], v[212:215]
    v_mfma_f32_16x16x32_bf16 v[216:219], v[100:103], v[40:43], v[216:219]
    v_mfma_f32_16x16x32_bf16 v[220:223], v[100:103], v[44:47], v[220:223]
    v_mfma_f32_16x16x32_bf16 v[224:227], v[104:107], v[32:35], v[224:227]
    v_mfma_f32_16x16x32_bf16 v[228:231], v[104:107], v[36:39], v[228:231]
    v_mfma_f32_16x16x32_bf16 v[232:235], v[104:107], v[40:43], v[232:235]
    v_mfma_f32_16x16x32_bf16 v[236:239], v[104:107], v[44:47], v[236:239]
    v_mfma_f32_16x16x32_bf16 v[240:243], v[108:111], v[32:35], v[240:243]
    v_mfma_f32_16x16x32_bf16 v[244:247], v[108:111], v[36:39], v[244:247]
    s_waitcnt lgkmcnt(6)
    v_mfma_f32_16x16x32_bf16 v[248:251], v[108:111], v[40:43], v[248:251]
    s_cmp_lg_u32 s51, s57
    v_mfma_f32_16x16x32_bf16 v[252:255], v[108:111], v[44:47], v[252:255]
    s_cbranch_scc1 L_gloop
    s_cmp_lg_u32 s56, 0
    s_cbranch_scc1 L_oepi
    s_waitcnt lgkmcnt(0)
    s_mov_b32 s78, 0x3e0293ee
    s_mov_b32 s79, 0x3e0293ee
    s_lshl_b32 s61, s50, 15
    s_lshl_b32 s62, s49, 14
    s_add_u32 s61, s61, s62
    v_add_u32 v14, s61, v2
    v_pk_mul_f32 v[128:129], v[128:129], s[78:79]
    v_pk_mul_f32 v[130:131], v[130:131], s[78:79]
    v_pk_mul_f32 v[144:145], v[144:145], s[78:79]
    v_pk_mul_f32 v[146:147], v[146:147], s[78:79]
    v_pk_mul_f32 v[132:133], v[132:133], s[78:79]
    v_pk_mul_f32 v[134:135], v[134:135], s[78:79]
    v_pk_mul_f32 v[148:149], v[148:149], s[78:79]
    v_pk_mul_f32 v[150:151], v[150:151], s[78:79]
    v_cvt_pk_bf16_f32 v16, v128, v129
    v_cvt_pk_bf16_f32 v17, v130, v131
    v_cvt_pk_bf16_f32 v18, v144, v145
    v_cvt_pk_bf16_f32 v19, v146, v147
    v_cvt_pk_bf16_f32 v20, v132, v133
    v_cvt_pk_bf16_f32 v21, v134, v135
    v_cvt_pk_bf16_f32 v22, v148, v149
    v_cvt_pk_bf16_f32 v23, v150, v151
    v_permlane16_swap_b32 v16, v18
    v_permlane16_swap_b32 v17, v19
    v_permlane16_swap_b32 v20, v22
    v_permlane16_swap_b32 v21, v23
    ds_write_b128 v14, v[16:19] offset:0
    ds_write_b128 v14, v[20:23] offset:4096
    v_pk_mul_f32 v[136:137], v[136:137], s[78:79]
    v_pk_mul_f32 v[138:139], v[138:139], s[78:79]
    v_pk_mul_f32 v[152:153], v[152:153], s[78:79]
    v_pk_mul_f32 v[154:155], v[154:155], s[78:79]
    v_pk_mul_f32 v[140:141], v[140:141], s[78:79]
    v_pk_mul_f32 v[142:143], v[142:143], s[78:79]
    v_pk_mul_f32 v[156:157], v[156:157], s[78:79]
    v_pk_mul_f32 v[158:159], v[158:159], s[78:79]
    v_cvt_pk_bf16_f32 v24, v136, v137
    v_cvt_pk_bf16_f32 v25, v138, v139
    v_cvt_pk_bf16_f32 v26, v152, v153
    v_cvt_pk_bf16_f32 v27, v154, v155
    v_cvt_pk_bf16_f32 v28, v140, v141
    v_cvt_pk_bf16_f32 v29, v142, v143
    v_cvt_pk_bf16_f32 v30, v156, v157
    v_cvt_pk_bf16_f32 v31, v158, v159
    v_permlane16_swap_b32 v24, v26
    v_permlane16_swap_b32 v25, v27
    v_permlane16_swap_b32 v28, v30
    v_permlane16_swap_b32 v29, v31
    ds_write_b128 v14, v[24:27] offset:8192
    ds_write_b128 v14, v[28:31] offset:12288
    v_pk_mul_f32 v[160:161], v[160:161], s[78:79]
    v_pk_mul_f32 v[162:163], v[162:163], s[78:79]
    v_pk_mul_f32 v[176:177], v[176:177], s[78:79]
    v_pk_mul_f32 v[178:179], v[178:179], s[78:79]
    v_pk_mul_f32 v[164:165], v[164:165], s[78:79]
    v_pk_mul_f32 v[166:167], v[166:167], s[78:79]
    v_pk_mul_f32 v[180:181], v[180:181], s[78:79]
    v_pk_mul_f32 v[182:183], v[182:183], s[78:79]
    v_cvt_pk_bf16_f32 v32, v160, v161
    v_cvt_pk_bf16_f32 v33, v162, v163
    v_cvt_pk_bf16_f32 v34, v176, v177
    v_cvt_pk_bf16_f32 v35, v178, v179
    v_cvt_pk_bf16_f32 v36, v164, v165
    v_cvt_pk_bf16_f32 v37, v166, v167
    v_cvt_pk_bf16_f32 v38, v180, v181
    v_cvt_pk_bf16_f32 v39, v182, v183
    v_permlane16_swap_b32 v32, v34
    v_permlane16_swap_b32 v33, v35
    v_permlane16_swap_b32 v36, v38
    v_permlane16_swap_b32 v37, v39
    ds_write_b128 v14, v[32:35] offset:1024
    ds_write_b128 v14, v[36:39] offset:5120
    v_pk_mul_f32 v[168:169], v[168:169], s[78:79]
    v_pk_mul_f32 v[170:171], v[170:171], s[78:79]
    v_pk_mul_f32 v[184:185], v[184:185], s[78:79]
    v_pk_mul_f32 v[186:187], v[186:187], s[78:79]
    v_pk_mul_f32 v[172:173], v[172:173], s[78:79]
    v_pk_mul_f32 v[174:175], v[174:175], s[78:79]
    v_pk_mul_f32 v[188:189], v[188:189], s[78:79]
    v_pk_mul_f32 v[190:191], v[190:191], s[78:79]
    v_cvt_pk_bf16_f32 v40, v168, v169
    v_cvt_pk_bf16_f32 v41, v170, v171
    v_cvt_pk_bf16_f32 v42, v184, v185
    v_cvt_pk_bf16_f32 v43, v186, v187
    v_cvt_pk_bf16_f32 v44, v172, v173
    v_cvt_pk_bf16_f32 v45, v174, v175
    v_cvt_pk_bf16_f32 v46, v188, v189
    v_cvt_pk_bf16_f32 v47, v190, v191
    v_permlane16_swap_b32 v40, v42
    v_permlane16_swap_b32 v41, v43
    v_permlane16_swap_b32 v44, v46
    v_permlane16_swap_b32 v45, v47
    ds_write_b128 v14, v[40:43] offset:9216
    ds_write_b128 v14, v[44:47] offset:13312
    v_pk_mul_f32 v[192:193], v[192:193], s[78:79]
    v_pk_mul_f32 v[194:195], v[194:195], s[78:79]
    v_pk_mul_f32 v[208:209], v[208:209], s[78:79]
    v_pk_mul_f32 v[210:211], v[210:211], s[78:79]
    v_pk_mul_f32 v[196:197], v[196:197], s[78:79]
    v_pk_mul_f32 v[198:199], v[198:199], s[78:79]
    v_pk_mul_f32 v[212:213], v[212:213], s[78:79]
    v_pk_mul_f32 v[214:215], v[214:215], s[78:79]
    v_cvt_pk_bf16_f32 v16, v192, v193
    v_cvt_pk_bf16_f32 v17, v194, v195
    v_cvt_pk_bf16_f32 v18, v208, v209
    v_cvt_pk_bf16_f32 v19, v210, v211
    v_cvt_pk_bf16_f32 v20, v196, v197
    v_cvt_pk_bf16_f32 v21, v198, v199
    v_cvt_pk_bf16_f32 v22, v212, v213
    v_cvt_pk_bf16_f32 v23, v214, v215
    v_permlane16_swap_b32 v16, v18
    v_permlane16_swap_b32 v17, v19
    v_permlane16_swap_b32 v20, v22
    v_permlane16_swap_b32 v21, v23
    ds_write_b128 v14, v[16:19] offset:2048
    ds_write_b128 v14, v[20:23] offset:6144
    v_pk_mul_f32 v[200:201], v[200:201], s[78:79]
    v_pk_mul_f32 v[202:203], v[202:203], s[78:79]
    v_pk_mul_f32 v[216:217], v[216:217], s[78:79]
    v_pk_mul_f32 v[218:219], v[218:219], s[78:79]
    v_pk_mul_f32 v[204:205], v[204:205], s[78:79]
    v_pk_mul_f32 v[206:207], v[206:207], s[78:79]
    v_pk_mul_f32 v[220:221], v[220:221], s[78:79]
    v_pk_mul_f32 v[222:223], v[222:223], s[78:79]
    v_cvt_pk_bf16_f32 v24, v200, v201
    v_cvt_pk_bf16_f32 v25, v202, v203
    v_cvt_pk_bf16_f32 v26, v216, v217
    v_cvt_pk_bf16_f32 v27, v218, v219
    v_cvt_pk_bf16_f32 v28, v204, v205
    v_cvt_pk_bf16_f32 v29, v206, v207
    v_cvt_pk_bf16_f32 v30, v220, v221
    v_cvt_pk_bf16_f32 v31, v222, v223
    v_permlane16_swap_b32 v24, v26
    v_permlane16_swap_b32 v25, v27
    v_permlane16_swap_b32 v28, v30
    v_permlane16_swap_b32 v29, v31
    ds_write_b128 v14, v[24:27] offset:10240
    ds_write_b128 v14, v[28:31] offset:14336
    v_pk_mul_f32 v[224:225], v[224:225], s[78:79]
    v_pk_mul_f32 v[226:227], v[226:227], s[78:79]
    v_pk_mul_f32 v[240:241], v[240:241], s[78:79]
    v_pk_mul_f32 v[242:243], v[242:243], s[78:79]
    v_pk_mul_f32 v[228:229], v[228:229], s[78:79]
    v_pk_mul_f32 v[230:231], v[230:231], s[78:79]
    v_pk_mul_f32 v[244:245], v[244:245], s[78:79]
    v_pk_mul_f32 v[246:247], v[246:247], s[78:79]
    v_cvt_pk_bf16_f32 v32, v224, v225
    v_cvt_pk_bf16_f32 v33, v226, v227
    v_cvt_pk_bf16_f32 v34, v240, v241
    v_cvt_pk_bf16_f32 v35, v242, v243
    v_cvt_pk_bf16_f32 v36, v228, v229
    v_cvt_pk_bf16_f32 v37, v230, v231
    v_cvt_pk_bf16_f32 v38, v244, v245
    v_cvt_pk_bf16_f32 v39, v246, v247
    v_permlane16_swap_b32 v32, v34
    v_permlane16_swap_b32 v33, v35
    v_permlane16_swap_b32 v36, v38
    v_permlane16_swap_b32 v37, v39
    ds_write_b128 v14, v[32:35] offset:3072
    ds_write_b128 v14, v[36:39] offset:7168
    v_pk_mul_f32 v[232:233], v[232:233], s[78:79]
    v_pk_mul_f32 v[234:235], v[234:235], s[78:79]
    v_pk_mul_f32 v[248:249], v[248:249], s[78:79]
    v_pk_mul_f32 v[250:251], v[250:251], s[78:79]
    v_pk_mul_f32 v[236:237], v[236:237], s[78:79]
    v_pk_mul_f32 v[238:239], v[238:239], s[78:79]
    v_pk_mul_f32 v[252:253], v[252:253], s[78:79]
    v_pk_mul_f32 v[254:255], v[254:255], s[78:79]
    v_cvt_pk_bf16_f32 v40, v232, v233
    v_cvt_pk_bf16_f32 v41, v234, v235
    v_cvt_pk_bf16_f32 v42, v248, v249
    v_cvt_pk_bf16_f32 v43, v250, v251
    v_cvt_pk_bf16_f32 v44, v236, v237
    v_cvt_pk_bf16_f32 v45, v238, v239
    v_cvt_pk_bf16_f32 v46, v252, v253
    v_cvt_pk_bf16_f32 v47, v254, v255
    v_permlane16_swap_b32 v40, v42
    v_permlane16_swap_b32 v41, v43
    v_permlane16_swap_b32 v44, v46
    v_permlane16_swap_b32 v45, v47
    ds_write_b128 v14, v[40:43] offset:11264
    ds_write_b128 v14, v[44:47] offset:15360
L_attn:
    v_lshrrev_b32 v48, 4, v0
    v_bfe_u32 v49, v0, 2, 2
    v_and_b32 v50, 3, v0
    v_sub_u32 v51, 0, v49
    v_and_b32 v51, 3, v51
    v_xor_b32 v51, v51, v48
    v_lshlrev_b32 v51, 4, v51
    v_lshl_add_u32 v51, v49, 11, v51
    v_lshl_add_u32 v51, v50, 6, v51
    v_add_u32 v240, 81920, v51
    v_lshlrev_b32 v51, 11, v48
    v_lshl_add_u32 v51, v49, 6, v51
    v_lshl_add_u32 v51, v50, 3, v51
    v_and_b32 v48, 1, v48
    v_lshl_add_u32 v51, v48, 5, v51
    v_add_u32 v241, 65536, v51
    v_xor_b32 v242, 32, v241
    s_lshl_b32 s3, s46, 13
    v_add_u32 v243, s3, v3
    s_lshl_b32 s3, s46, 12
    v_add_u32 v244, s3, v2
    v_add_u32 v245, 114688, v244
    v_mov_b32 v208, 0x3f803f80
    v_mov_b32 v209, 0x3f803f80
    v_mov_b32 v210, 0x3f803f80
    v_mov_b32 v211, 0x3f803f80
    s_mov_b32 s51, 0
    s_mov_b32 s52, 0
    s_mov_b32 s54, 32768
    s_mov_b32 s55, -65536
    s_mov_b32 s65, 0x40004000
    s_lshl_b32 s3, s49, 13
    s_add_u32 s3, s3, 16384
    v_add_u32 v4, s3, v3
    v_add_u32 v5, 1024, v4
    s_xor_b32 s61, s43, 0
    s_lshr_b32 s62, s61, 1
    s_lshl_b32 s62, s62, 14
    s_add_u32 s62, s62, 32768
    s_and_b32 s61, s61, 1
    s_lshl_b32 s61, s61, 1
    s_add_u32 s61, s61, s50
    s_lshl_b32 s61, s61, 6
    v_xor_b32 v6, s61, v1
    v_add_u32 v6, s62, v6
    v_xor_b32 v7, 32, v6
    s_xor_b32 s61, s43, 1
    s_lshr_b32 s62, s61, 1
    s_lshl_b32 s62, s62, 14
    s_add_u32 s62, s62, 32768
    s_and_b32 s61, s61, 1
    s_lshl_b32 s61, s61, 1
    s_add_u32 s61, s61, s50
    s_lshl_b32 s61, s61, 6
    v_xor_b32 v8, s61, v1
    v_add_u32 v8, s62, v8
    v_xor_b32 v9, 32, v8
    s_xor_b32 s61, s43, 2
    s_lshr_b32 s62, s61, 1
    s_lshl_b32 s62, s62, 14
    s_add_u32 s62, s62, 32768
    s_and_b32 s61, s61, 1
    s_lshl_b32 s61, s61, 1
    s_add_u32 s61, s61, s50
    s_lshl_b32 s61, s61, 6
    v_xor_b32 v10, s61, v1
    v_add_u32 v10, s62, v10
    v_xor_b32 v11, 32, v10
    s_xor_b32 s61, s43, 3
    s_lshr_b32 s62, s61, 1
    s_lshl_b32 s62, s62, 14
    s_add_u32 s62, s62, 32768
    s_and_b32 s61, s61, 1
    s_lshl_b32 s61, s61, 1
    s_add_u32 s61, s61, s50
    s_lshl_b32 s61, s61, 6
    v_xor_b32 v12, s61, v1
    v_add_u32 v12, s62, v12
    v_xor_b32 v13, 32, v12
    s_waitcnt lgkmcnt(0)
    s_barrier
    ds_read_b128 v[16:19], v243 offset:0
    ds_read_b128 v[20:23], v243 offset:1024
    ds_read_b128 v[24:27], v243 offset:2048
    ds_read_b128 v[28:31], v243 offset:3072
    ds_read_b128 v[32:35], v243 offset:4096
    ds_read_b128 v[36:39], v243 offset:5120
    ds_read_b128 v[40:43], v243 offset:6144
    ds_read_b128 v[44:47], v243 offset:7168
    s_barrier
    ds_read_b128 v[48:51], v240 offset:0
    ds_read_b128 v[52:55], v240 offset:1024
    ds_read_b128 v[56:59], v240 offset:256
    ds_read_b128 v[60:63], v240 offset:1280
    ds_read_b128 v[64:67], v240 offset:512
    v_mov_b64 v[128:129], 0
    v_mov_b64 v[130:131], 0
    v_mov_b64 v[132:133], 0
    v_mov_b64 v[134:135], 0
    v_mov_b64 v[136:137], 0
    v_mov_b64 v[138:139], 0
    v_mov_b64 v[140:141], 0
    v_mov_b64 v[142:143], 0
    v_mov_b64 v[144:145], 0
    v_mov_b64 v[146:147], 0
    v_mov_b64 v[148:149], 0
    v_mov_b64 v[150:151], 0
    v_mov_b64 v[152:153], 0
    v_mov_b64 v[154:155], 0
    v_mov_b64 v[156:157], 0
    v_mov_b64 v[158:159], 0
    s_waitcnt lgkmcnt(5)
    s_waitcnt lgkmcnt(3)
    v_mfma_f32_16x16x32_bf16 v[80:83], v[48:51], v[16:19], 0
    ds_read_b128 v[68:71], v240 offset:1536
    v_mfma_f32_16x16x32_bf16 v[84:87], v[48:51], v[32:35], 0
    v_mfma_f32_16x16x32_bf16 v[88:91], v[52:55], v[16:19], 0
    ds_read_b128 v[72:75], v240 offset:768
    v_mfma_f32_16x16x32_bf16 v[92:95], v[52:55], v[32:35], 0
    s_waitcnt lgkmcnt(3)
    v_mov_b64 v[160:161], 0
    v_mov_b64 v[162:163], 0
    v_mfma_f32_16x16x32_bf16 v[80:83], v[56:59], v[20:23], v[80:83]
    ds_read_b128 v[76:79], v240 offset:1792
    v_mov_b64 v[164:165], 0
    v_mfma_f32_16x16x32_bf16 v[84:87], v[56:59], v[36:39], v[84:87]
    v_mov_b64 v[166:167], 0
    v_mov_b64 v[168:169], 0
    v_mfma_f32_16x16x32_bf16 v[88:91], v[60:63], v[20:23], v[88:91]
    ds_read_b128 v[48:51], v240 offset:8192
    v_mov_b64 v[170:171], 0
    v_mfma_f32_16x16x32_bf16 v[92:95], v[60:63], v[36:39], v[92:95]
    s_waitcnt lgkmcnt(3)
    v_mov_b64 v[172:173], 0
    v_mov_b64 v[174:175], 0
    v_mfma_f32_16x16x32_bf16 v[80:83], v[64:67], v[24:27], v[80:83]
    ds_read_b128 v[52:55], v240 offset:9216
    v_mov_b64 v[176:177], 0
    v_mfma_f32_16x16x32_bf16 v[84:87], v[64:67], v[40:43], v[84:87]
    v_mov_b64 v[178:179], 0
    v_mov_b64 v[180:181], 0
    v_mfma_f32_16x16x32_bf16 v[88:91], v[68:71], v[24:27], v[88:91]
    ds_read_b128 v[56:59], v240 offset:8448
    v_mov_b64 v[182:183], 0
    v_mfma_f32_16x16x32_bf16 v[92:95], v[68:71], v[40:43], v[92:95]
    s_waitcnt lgkmcnt(3)
    v_mov_b64 v[184:185], 0
    v_mov_b64 v[186:187], 0
    v_mfma_f32_16x16x32_bf16 v[80:83], v[72:75], v[28:31], v[80:83]
    ds_read_b128 v[60:63], v240 offset:9472
    v_mov_b64 v[188:189], 0
    v_mfma_f32_16x16x32_bf16 v[84:87], v[72:75], v[44:47], v[84:87]
    v_mov_b64 v[190:191], 0
    v_mov_b64 v[200:201], 0
    v_mfma_f32_16x16x32_bf16 v[88:91], v[76:79], v[28:31], v[88:91]
    ds_read_b128 v[64:67], v240 offset:8704
    v_mov_b64 v[202:203], 0
    v_mfma_f32_16x16x32_bf16 v[92:95], v[76:79], v[44:47], v[92:95]
    v_mov_b64 v[204:205], 0
    v_mov_b64 v[206:207], 0
    s_nop 1
    s_add_u32 s52, s52, 1
    s_cmp_eq_u32 s52, 3
    s_cselect_b32 s53, s55, s54
    s_cselect_b32 s52, 0, s52
    v_max3_f32 v247, v80, v81, v82
    v_max3_f32 v247, v247, v83, v88
    v_max3_f32 v247, v247, v89, v90
    v_max_f32 v247, v247, v91
    v_max3_f32 v248, v84, v85, v86
    v_max3_f32 v248, v248, v87, v92
    v_max3_f32 v248, v248, v93, v94
    v_max_f32 v248, v248, v95
    v_mov_b32 v249, v247
    v_mov_b32 v250, v248
    s_nop 0
    v_permlane16_swap_b32 v247, v249
    v_permlane16_swap_b32 v248, v250
    s_nop 0
    v_max_f32 v247, v247, v249
    v_max_f32 v248, v248, v250
    v_mov_b32 v249, v247
    v_mov_b32 v250, v248
    s_nop 0
    v_permlane32_swap_b32 v247, v249
    v_permlane32_swap_b32 v248, v250
    s_nop 0
    v_max_f32 v247, v247, v249
    v_max_f32 v248, v248, v250
    v_add_f32 v247, 0x40e00000, v247
    v_add_f32 v248, 0x40e00000, v248
    v_sub_f32 v192, 0, v247
    v_sub_f32 v193, 0, v247
    v_sub_f32 v194, 0, v247
    v_sub_f32 v195, 0, v247
    v_sub_f32 v196, 0, v248
    v_sub_f32 v197, 0, v248
    v_sub_f32 v198, 0, v248
    v_sub_f32 v199, 0, v248
    v_sub_f32 v80, v80, v247
    v_sub_f32 v81, v81, v247
    v_sub_f32 v82, v82, v247
    v_sub_f32 v83, v83, v247
    v_sub_f32 v88, v88, v247
    v_sub_f32 v89, v89, v247
    v_sub_f32 v90, v90, v247
    v_sub_f32 v91, v91, v247
    v_sub_f32 v84, v84, v248
    v_sub_f32 v85, v85, v248
    v_sub_f32 v86, v86, v248
    v_sub_f32 v87, v87, v248
    v_sub_f32 v92, v92, v248
    v_sub_f32 v93, v93, v248
    v_sub_f32 v94, v94, v248
    v_sub_f32 v95, v95, v248
    s_waitcnt lgkmcnt(3)
    v_mfma_f32_16x16x32_bf16 v[96:99], v[48:51], v[16:19], v[192:195]
    ds_read_b128 v[68:71], v240 offset:9728
    v_exp_f32 v212, v80
    v_mfma_f32_16x16x32_bf16 v[100:103], v[48:51], v[32:35], v[196:199]
    v_exp_f32 v213, v81
    v_mfma_f32_16x16x32_bf16 v[104:107], v[52:55], v[16:19], v[192:195]
    ds_read_b128 v[72:75], v240 offset:8960
    v_exp_f32 v214, v82
    v_mfma_f32_16x16x32_bf16 v[108:111], v[52:55], v[32:35], v[196:199]
    s_waitcnt lgkmcnt(3)
    v_cvt_pk_bf16_f32 v112, v212, v213
    v_exp_f32 v215, v83
    v_mfma_f32_16x16x32_bf16 v[96:99], v[56:59], v[20:23], v[96:99]
    ds_read_b128 v[76:79], v240 offset:9984
    v_exp_f32 v216, v88
    v_mfma_f32_16x16x32_bf16 v[100:103], v[56:59], v[36:39], v[100:103]
    v_add_u32 v240, s53, v240
    v_cvt_pk_bf16_f32 v113, v214, v215
    v_mfma_f32_16x16x32_bf16 v[104:107], v[60:63], v[20:23], v[104:107]
    s_barrier
    ds_read_b128 v[48:51], v240 offset:0
    v_exp_f32 v217, v89
    v_mfma_f32_16x16x32_bf16 v[108:111], v[60:63], v[36:39], v[108:111]
    s_waitcnt lgkmcnt(3)
    v_exp_f32 v218, v90
    v_mfma_f32_16x16x32_bf16 v[96:99], v[64:67], v[24:27], v[96:99]
    ds_read_b128 v[52:55], v240 offset:1024
    v_cvt_pk_bf16_f32 v114, v216, v217
    v_mfma_f32_16x16x32_bf16 v[100:103], v[64:67], v[40:43], v[100:103]
    v_exp_f32 v219, v91
    v_mfma_f32_16x16x32_bf16 v[104:107], v[68:71], v[24:27], v[104:107]
    ds_read_b128 v[56:59], v240 offset:256
    v_exp_f32 v212, v84
    v_mfma_f32_16x16x32_bf16 v[108:111], v[68:71], v[40:43], v[108:111]
    s_waitcnt lgkmcnt(3)
    v_cvt_pk_bf16_f32 v115, v218, v219
    v_exp_f32 v213, v85
    v_mfma_f32_16x16x32_bf16 v[96:99], v[72:75], v[28:31], v[96:99]
    ds_read_b128 v[60:63], v240 offset:1280
    v_exp_f32 v214, v86
    v_cvt_pk_bf16_f32 v116, v212, v213
    v_mfma_f32_16x16x32_bf16 v[100:103], v[72:75], v[44:47], v[100:103]
    v_exp_f32 v215, v87
    v_exp_f32 v216, v92
    v_cvt_pk_bf16_f32 v117, v214, v215
    v_mfma_f32_16x16x32_bf16 v[104:107], v[76:79], v[28:31], v[104:107]
    ds_read_b128 v[64:67], v240 offset:512
    v_exp_f32 v217, v93
    v_exp_f32 v218, v94
    v_cvt_pk_bf16_f32 v118, v216, v217
    v_mfma_f32_16x16x32_bf16 v[108:111], v[76:79], v[44:47], v[108:111]
    v_exp_f32 v219, v95
    s_nop 0
    v_cvt_pk_bf16_f32 v119, v218, v219
    s_mov_b32 s58, 0
    s_waitcnt lgkmcnt(3)
    .p2align 3
L_aloop:
    v_mfma_f32_16x16x32_bf16 v[80:83], v[48:51], v[16:19], v[192:195]
    s_add_u32 s51, s51, 1
    ds_read_b128 v[68:71], v240 offset:1536
    v_add_u32 v241, s58, v241
    v_mfma_f32_16x16x32_bf16 v[84:87], v[48:51], v[32:35], v[196:199]
    v_add_u32 v242, s58, v242
    v_exp_f32 v212, v96
    v_mfma_f32_16x16x32_bf16 v[88:91], v[52:55], v[16:19], v[192:195]
    ds_read_b128 v[72:75], v240 offset:768
    v_exp_f32 v213, v97
    v_mfma_f32_16x16x32_bf16 v[92:95], v[52:55], v[32:35], v[196:199]
    s_waitcnt lgkmcnt(3)
    v_exp_f32 v214, v98
    v_mfma_f32_16x16x32_bf16 v[80:83], v[56:59], v[20:23], v[80:83]
    s_and_b32 s3, s51, 7
    ds_read_b128 v[76:79], v240 offset:1792
    v_cvt_pk_bf16_f32 v120, v212, v213
    v_mfma_f32_16x16x32_bf16 v[84:87], v[56:59], v[36:39], v[84:87]
    v_exp_f32 v215, v99
    v_mfma_f32_16x16x32_bf16 v[88:91], v[60:63], v[20:23], v[88:91]
    s_mov_b32 s58, s53
    s_barrier
    ds_read_b64_tr_b16 v[48:49], v241 offset:0
    ds_read_b64_tr_b16 v[50:51], v241 offset:1024
    v_mfma_f32_16x16x32_bf16 v[92:95], v[60:63], v[36:39], v[92:95]
    s_waitcnt lgkmcnt(4)
    v_exp_f32 v216, v104
    v_mfma_f32_16x16x32_bf16 v[80:83], v[64:67], v[24:27], v[80:83]
    ds_read_b64_tr_b16 v[52:53], v242 offset:0
    ds_read_b64_tr_b16 v[54:55], v242 offset:1024
    v_mfma_f32_16x16x32_bf16 v[84:87], v[64:67], v[40:43], v[84:87]
    v_cvt_pk_bf16_f32 v121, v214, v215
    v_mfma_f32_16x16x32_bf16 v[88:91], v[68:71], v[24:27], v[88:91]
    ds_read_b64_tr_b16 v[56:57], v241 offset:256
    ds_read_b64_tr_b16 v[58:59], v241 offset:1280
    v_mfma_f32_16x16x32_bf16 v[92:95], v[68:71], v[40:43], v[92:95]
    s_waitcnt lgkmcnt(6)
    v_exp_f32 v217, v105
    v_mfma_f32_16x16x32_bf16 v[80:83], v[72:75], v[28:31], v[80:83]
    ds_read_b64_tr_b16 v[60:61], v242 offset:256
    ds_read_b64_tr_b16 v[62:63], v242 offset:1280
    v_mfma_f32_16x16x32_bf16 v[84:87], v[72:75], v[44:47], v[84:87]
    v_exp_f32 v218, v106
    v_mfma_f32_16x16x32_bf16 v[88:91], v[76:79], v[28:31], v[88:91]
    ds_read_b64_tr_b16 v[64:65], v241 offset:512
    ds_read_b64_tr_b16 v[66:67], v241 offset:1536
    v_mfma_f32_16x16x32_bf16 v[92:95], v[76:79], v[44:47], v[92:95]
    v_cvt_pk_bf16_f32 v122, v216, v217
    v_exp_f32 v219, v107
    v_mfma_f32_16x16x32_bf16 v[200:203], v[208:211], v[112:115], v[200:203]
    v_exp_f32 v212, v100
    v_mfma_f32_16x16x32_bf16 v[204:207], v[208:211], v[116:119], v[204:207]
    s_waitcnt lgkmcnt(6)
    v_cvt_pk_bf16_f32 v123, v218, v219
    v_exp_f32 v213, v101
    v_mfma_f32_16x16x32_bf16 v[128:131], v[48:51], v[112:115], v[128:131]
    ds_read_b64_tr_b16 v[68:69], v242 offset:512
    ds_read_b64_tr_b16 v[70:71], v242 offset:1536
    v_mfma_f32_16x16x32_bf16 v[132:135], v[48:51], v[116:119], v[132:135]
    v_or3_b32 v246, v120, v121, v122
    v_exp_f32 v214, v102
    v_mfma_f32_16x16x32_bf16 v[136:139], v[52:55], v[112:115], v[136:139]
    ds_read_b64_tr_b16 v[72:73], v241 offset:768
    ds_read_b64_tr_b16 v[74:75], v241 offset:1792
    v_mfma_f32_16x16x32_bf16 v[140:143], v[52:55], v[116:119], v[140:143]
    s_waitcnt lgkmcnt(6)
    v_cvt_pk_bf16_f32 v124, v212, v213
    v_exp_f32 v215, v103
    v_mfma_f32_16x16x32_bf16 v[144:147], v[56:59], v[112:115], v[144:147]
    ds_read_b64_tr_b16 v[76:77], v242 offset:768
    ds_read_b64_tr_b16 v[78:79], v242 offset:1792
    v_mfma_f32_16x16x32_bf16 v[148:151], v[56:59], v[116:119], v[148:151]
    v_exp_f32 v216, v108
    v_mfma_f32_16x16x32_bf16 v[152:155], v[60:63], v[112:115], v[152:155]
    ds_read_b128 v[48:51], v240 offset:8192
    v_cvt_pk_bf16_f32 v125, v214, v215
    v_mfma_f32_16x16x32_bf16 v[156:159], v[60:63], v[116:119], v[156:159]
    s_waitcnt lgkmcnt(5)
    v_exp_f32 v217, v109
    v_mfma_f32_16x16x32_bf16 v[160:163], v[64:67], v[112:115], v[160:163]
    ds_read_b128 v[52:55], v240 offset:9216
    v_or3_b32 v246, v246, v123, v124
    v_mfma_f32_16x16x32_bf16 v[164:167], v[64:67], v[116:119], v[164:167]
    v_exp_f32 v218, v110
    v_mfma_f32_16x16x32_bf16 v[168:171], v[68:71], v[112:115], v[168:171]
    ds_read_b128 v[56:59], v240 offset:8448
    v_cvt_pk_bf16_f32 v126, v216, v217
    v_mfma_f32_16x16x32_bf16 v[172:175], v[68:71], v[116:119], v[172:175]
    s_waitcnt lgkmcnt(3)
    v_exp_f32 v219, v111
    v_mfma_f32_16x16x32_bf16 v[176:179], v[72:75], v[112:115], v[176:179]
    ds_read_b128 v[60:63], v240 offset:9472
    v_or3_b32 v246, v246, v125, v126
    v_mfma_f32_16x16x32_bf16 v[180:183], v[72:75], v[116:119], v[180:183]
    v_cvt_pk_bf16_f32 v127, v218, v219
    v_bitop3_b32 v246, v246, v127, s65 bitop3:0xa8
    v_mfma_f32_16x16x32_bf16 v[184:187], v[76:79], v[112:115], v[184:187]
    s_waitcnt lgkmcnt(2)
    ds_read_b128 v[64:67], v240 offset:8704
    v_cmp_ne_u32 vcc, 0, v246
    v_mfma_f32_16x16x32_bf16 v[188:191], v[76:79], v[116:119], v[188:191]
    s_cbranch_vccnz L_slow_8
L_slow_8_ret:
    v_mfma_f32_16x16x32_bf16 v[96:99], v[48:51], v[16:19], v[192:195]
    s_add_u32 s52, s52, 1
    ds_read_b128 v[68:71], v240 offset:9728
    v_mfma_f32_16x16x32_bf16 v[100:103], v[48:51], v[32:35], v[196:199]
    v_exp_f32 v212, v80
    v_mfma_f32_16x16x32_bf16 v[104:107], v[52:55], v[16:19], v[192:195]
    s_cmp_eq_u32 s52, 3
    ds_read_b128 v[72:75], v240 offset:8960
    v_exp_f32 v213, v81
    v_mfma_f32_16x16x32_bf16 v[108:111], v[52:55], v[32:35], v[196:199]
    s_waitcnt lgkmcnt(3)
    v_exp_f32 v214, v82
    v_mfma_f32_16x16x32_bf16 v[96:99], v[56:59], v[20:23], v[96:99]
    s_cselect_b32 s53, s55, s54
    ds_read_b128 v[76:79], v240 offset:9984
    v_cvt_pk_bf16_f32 v112, v212, v213
    v_mfma_f32_16x16x32_bf16 v[100:103], v[56:59], v[36:39], v[100:103]
    v_exp_f32 v215, v83
    v_mfma_f32_16x16x32_bf16 v[104:107], v[60:63], v[20:23], v[104:107]
    s_cselect_b32 s52, 0, s52
    ds_read_b64_tr_b16 v[48:49], v241 offset:8192
    ds_read_b64_tr_b16 v[50:51], v241 offset:9216
    v_mfma_f32_16x16x32_bf16 v[108:111], v[60:63], v[36:39], v[108:111]
    s_waitcnt lgkmcnt(4)
    v_exp_f32 v216, v88
    v_mfma_f32_16x16x32_bf16 v[96:99], v[64:67], v[24:27], v[96:99]
    ds_read_b64_tr_b16 v[52:53], v242 offset:8192
    ds_read_b64_tr_b16 v[54:55], v242 offset:9216
    v_mfma_f32_16x16x32_bf16 v[100:103], v[64:67], v[40:43], v[100:103]
    v_cvt_pk_bf16_f32 v113, v214, v215
    v_mfma_f32_16x16x32_bf16 v[104:107], v[68:71], v[24:27], v[104:107]
    ds_read_b64_tr_b16 v[56:57], v241 offset:8448
    ds_read_b64_tr_b16 v[58:59], v241 offset:9472
    v_mfma_f32_16x16x32_bf16 v[108:111], v[68:71], v[40:43], v[108:111]
    s_waitcnt lgkmcnt(6)
    v_exp_f32 v217, v89
    v_mfma_f32_16x16x32_bf16 v[96:99], v[72:75], v[28:31], v[96:99]
    ds_read_b64_tr_b16 v[60:61], v242 offset:8448
    ds_read_b64_tr_b16 v[62:63], v242 offset:9472
    v_mfma_f32_16x16x32_bf16 v[100:103], v[72:75], v[44:47], v[100:103]
    v_exp_f32 v218, v90
    v_mfma_f32_16x16x32_bf16 v[104:107], v[76:79], v[28:31], v[104:107]
    ds_read_b64_tr_b16 v[64:65], v241 offset:8704
    ds_read_b64_tr_b16 v[66:67], v241 offset:9728
    v_mfma_f32_16x16x32_bf16 v[108:111], v[76:79], v[44:47], v[108:111]
    v_cvt_pk_bf16_f32 v114, v216, v217
    v_exp_f32 v219, v91
    v_mfma_f32_16x16x32_bf16 v[200:203], v[208:211], v[120:123], v[200:203]
    v_exp_f32 v212, v84
    v_mfma_f32_16x16x32_bf16 v[204:207], v[208:211], v[124:127], v[204:207]
    s_waitcnt lgkmcnt(6)
    v_cvt_pk_bf16_f32 v115, v218, v219
    v_exp_f32 v213, v85
    v_mfma_f32_16x16x32_bf16 v[128:131], v[48:51], v[120:123], v[128:131]
    ds_read_b64_tr_b16 v[68:69], v242 offset:8704
    ds_read_b64_tr_b16 v[70:71], v242 offset:9728
    v_mfma_f32_16x16x32_bf16 v[132:135], v[48:51], v[124:127], v[132:135]
    v_or3_b32 v246, v112, v113, v114
    v_exp_f32 v214, v86
    v_mfma_f32_16x16x32_bf16 v[136:139], v[52:55], v[120:123], v[136:139]
    ds_read_b64_tr_b16 v[72:73], v241 offset:8960
    ds_read_b64_tr_b16 v[74:75], v241 offset:9984
    v_mfma_f32_16x16x32_bf16 v[140:143], v[52:55], v[124:127], v[140:143]
    s_waitcnt lgkmcnt(6)
    v_cvt_pk_bf16_f32 v116, v212, v213
    v_exp_f32 v215, v87
    v_mfma_f32_16x16x32_bf16 v[144:147], v[56:59], v[120:123], v[144:147]
    ds_read_b64_tr_b16 v[76:77], v242 offset:8960
    ds_read_b64_tr_b16 v[78:79], v242 offset:9984
    v_mfma_f32_16x16x32_bf16 v[148:151], v[56:59], v[124:127], v[148:151]
    v_add_u32 v240, s53, v240
    v_exp_f32 v216, v92
    v_mfma_f32_16x16x32_bf16 v[152:155], v[60:63], v[120:123], v[152:155]
    s_barrier
    ds_read_b128 v[48:51], v240 offset:0
    v_cvt_pk_bf16_f32 v117, v214, v215
    v_mfma_f32_16x16x32_bf16 v[156:159], v[60:63], v[124:127], v[156:159]
    s_waitcnt lgkmcnt(5)
    v_exp_f32 v217, v93
    v_mfma_f32_16x16x32_bf16 v[160:163], v[64:67], v[120:123], v[160:163]
    ds_read_b128 v[52:55], v240 offset:1024
    v_or3_b32 v246, v246, v115, v116
    v_mfma_f32_16x16x32_bf16 v[164:167], v[64:67], v[124:127], v[164:167]
    v_exp_f32 v218, v94
    v_mfma_f32_16x16x32_bf16 v[168:171], v[68:71], v[120:123], v[168:171]
    ds_read_b128 v[56:59], v240 offset:256
    v_cvt_pk_bf16_f32 v118, v216, v217
    v_mfma_f32_16x16x32_bf16 v[172:175], v[68:71], v[124:127], v[172:175]
    s_waitcnt lgkmcnt(3)
    v_exp_f32 v219, v95
    v_mfma_f32_16x16x32_bf16 v[176:179], v[72:75], v[120:123], v[176:179]
    s_cmp_lg_u32 s3, 7
    ds_read_b128 v[60:63], v240 offset:1280
    v_or3_b32 v246, v246, v117, v118
    v_mfma_f32_16x16x32_bf16 v[180:183], v[72:75], v[124:127], v[180:183]
    v_cvt_pk_bf16_f32 v119, v218, v219
    v_bitop3_b32 v246, v246, v119, s65 bitop3:0xa8
    v_mfma_f32_16x16x32_bf16 v[184:187], v[76:79], v[120:123], v[184:187]
    s_waitcnt lgkmcnt(2)
    ds_read_b128 v[64:67], v240 offset:512
    v_cmp_ne_u32 vcc, 0, v246
    v_mfma_f32_16x16x32_bf16 v[188:191], v[76:79], v[124:127], v[188:191]
    s_cbranch_vccnz L_slow_9
L_slow_9_ret:
    s_cbranch_scc1 L_aloop
    s_add_u32 s51, s51, 1
    v_add_u32 v241, s58, v241
    v_add_u32 v242, s58, v242
    s_cmp_eq_u32 s51, 16
    s_cbranch_scc1 L_atail
    ds_read_b128 v[16:19], v243 offset:32768
    ds_read_b128 v[20:23], v243 offset:33792
    ds_read_b128 v[24:27], v243 offset:34816
    ds_read_b128 v[28:31], v243 offset:35840
    ds_read_b128 v[32:35], v243 offset:36864
    ds_read_b128 v[36:39], v243 offset:37888
    ds_read_b128 v[40:43], v243 offset:38912
    ds_read_b128 v[44:47], v243 offset:39936
    s_mov_b32 s58, s53
    v_exp_f32 v212, v96
    v_exp_f32 v213, v97
    v_exp_f32 v214, v98
    v_cvt_pk_bf16_f32 v120, v212, v213
    v_exp_f32 v215, v99
    v_exp_f32 v216, v104
    v_cvt_pk_bf16_f32 v121, v214, v215
    v_exp_f32 v217, v105
    v_exp_f32 v218, v106
    v_cvt_pk_bf16_f32 v122, v216, v217
    s_waitcnt lgkmcnt(0)
    v_mfma_f32_16x16x32_bf16 v[80:83], v[48:51], v[16:19], 0
    ds_read_b128 v[68:71], v240 offset:1536
    v_exp_f32 v219, v107
    v_mfma_f32_16x16x32_bf16 v[84:87], v[48:51], v[32:35], 0
    v_exp_f32 v212, v100
    v_mfma_f32_16x16x32_bf16 v[88:91], v[52:55], v[16:19], 0
    ds_read_b128 v[72:75], v240 offset:768
    v_cvt_pk_bf16_f32 v123, v218, v219
    v_mfma_f32_16x16x32_bf16 v[92:95], v[52:55], v[32:35], 0
    v_exp_f32 v213, v101
    v_mfma_f32_16x16x32_bf16 v[80:83], v[56:59], v[20:23], v[80:83]
    ds_read_b128 v[76:79], v240 offset:1792
    v_or3_b32 v246, v120, v121, v122
    v_mfma_f32_16x16x32_bf16 v[84:87], v[56:59], v[36:39], v[84:87]
    v_exp_f32 v214, v102
    v_mfma_f32_16x16x32_bf16 v[88:91], v[60:63], v[20:23], v[88:91]
    s_barrier
    ds_read_b64_tr_b16 v[48:49], v241 offset:0
    ds_read_b64_tr_b16 v[50:51], v241 offset:1024
    v_mfma_f32_16x16x32_bf16 v[92:95], v[60:63], v[36:39], v[92:95]
    s_waitcnt lgkmcnt(4)
    v_cvt_pk_bf16_f32 v124, v212, v213
    v_mfma_f32_16x16x32_bf16 v[80:83], v[64:67], v[24:27], v[80:83]
    ds_read_b64_tr_b16 v[52:53], v242 offset:0
    ds_read_b64_tr_b16 v[54:55], v242 offset:1024
    v_mfma_f32_16x16x32_bf16 v[84:87], v[64:67], v[40:43], v[84:87]
    v_exp_f32 v215, v103
    v_mfma_f32_16x16x32_bf16 v[88:91], v[68:71], v[24:27], v[88:91]
    ds_read_b64_tr_b16 v[56:57], v241 offset:256
    ds_read_b64_tr_b16 v[58:59], v241 offset:1280
    v_mfma_f32_16x16x32_bf16 v[92:95], v[68:71], v[40:43], v[92:95]
    s_waitcnt lgkmcnt(6)
    v_exp_f32 v216, v108
    v_mfma_f32_16x16x32_bf16 v[80:83], v[72:75], v[28:31], v[80:83]
    ds_read_b64_tr_b16 v[60:61], v242 offset:256
    ds_read_b64_tr_b16 v[62:63], v242 offset:1280
    v_mfma_f32_16x16x32_bf16 v[84:87], v[72:75], v[44:47], v[84:87]
    v_cvt_pk_bf16_f32 v125, v214, v215
    v_exp_f32 v217, v109
    v_mfma_f32_16x16x32_bf16 v[88:91], v[76:79], v[28:31], v[88:91]
    ds_read_b64_tr_b16 v[64:65], v241 offset:512
    ds_read_b64_tr_b16 v[66:67], v241 offset:1536
    v_mfma_f32_16x16x32_bf16 v[92:95], v[76:79], v[44:47], v[92:95]
    v_or3_b32 v246, v246, v123, v124
    v_exp_f32 v218, v110
    v_mfma_f32_16x16x32_bf16 v[200:203], v[208:211], v[112:115], v[200:203]
    v_cvt_pk_bf16_f32 v126, v216, v217
    v_exp_f32 v219, v111
    v_mfma_f32_16x16x32_bf16 v[204:207], v[208:211], v[116:119], v[204:207]
    s_waitcnt lgkmcnt(6)
    v_or3_b32 v246, v246, v125, v126
    v_cvt_pk_bf16_f32 v127, v218, v219
    v_mfma_f32_16x16x32_bf16 v[128:131], v[48:51], v[112:115], v[128:131]
    ds_read_b64_tr_b16 v[68:69], v242 offset:512
    ds_read_b64_tr_b16 v[70:71], v242 offset:1536
    v_mfma_f32_16x16x32_bf16 v[132:135], v[48:51], v[116:119], v[132:135]
    v_bitop3_b32 v246, v246, v127, s65 bitop3:0xa8
    v_cmp_ne_u32 vcc, 0, v246
    v_mfma_f32_16x16x32_bf16 v[136:139], v[52:55], v[112:115], v[136:139]
    ds_read_b64_tr_b16 v[72:73], v241 offset:768
    ds_read_b64_tr_b16 v[74:75], v241 offset:1792
    v_mfma_f32_16x16x32_bf16 v[140:143], v[52:55], v[116:119], v[140:143]
    s_waitcnt lgkmcnt(6)
    v_max3_f32 v247, v80, v81, v82
    v_max3_f32 v247, v247, v83, v88
    v_mfma_f32_16x16x32_bf16 v[144:147], v[56:59], v[112:115], v[144:147]
    ds_read_b64_tr_b16 v[76:77], v242 offset:768
    ds_read_b64_tr_b16 v[78:79], v242 offset:1792
    v_mfma_f32_16x16x32_bf16 v[148:151], v[56:59], v[116:119], v[148:151]
    v_max3_f32 v247, v247, v89, v90
    v_max_f32 v247, v247, v91
    v_mfma_f32_16x16x32_bf16 v[152:155], v[60:63], v[112:115], v[152:155]
    ds_read_b64_tr_b16 v[48:49], v241 offset:8192
    ds_read_b64_tr_b16 v[50:51], v241 offset:9216
    v_mfma_f32_16x16x32_bf16 v[156:159], v[60:63], v[116:119], v[156:159]
    s_waitcnt lgkmcnt(6)
    v_max3_f32 v248, v84, v85, v86
    v_max3_f32 v248, v248, v87, v92
    v_mfma_f32_16x16x32_bf16 v[160:163], v[64:67], v[112:115], v[160:163]
    ds_read_b64_tr_b16 v[52:53], v242 offset:8192
    ds_read_b64_tr_b16 v[54:55], v242 offset:9216
    v_mfma_f32_16x16x32_bf16 v[164:167], v[64:67], v[116:119], v[164:167]
    v_max3_f32 v248, v248, v93, v94
    v_max_f32 v248, v248, v95
    v_mfma_f32_16x16x32_bf16 v[168:171], v[68:71], v[112:115], v[168:171]
    ds_read_b64_tr_b16 v[56:57], v241 offset:8448
    ds_read_b64_tr_b16 v[58:59], v241 offset:9472
    v_mov_b32 v249, v247
    v_mov_b32 v250, v248
    s_nop 0
    v_permlane16_swap_b32 v247, v249
    v_permlane16_swap_b32 v248, v250
    s_nop 0
    v_max_f32 v247, v247, v249
    v_mfma_f32_16x16x32_bf16 v[172:175], v[68:71], v[116:119], v[172:175]
    s_waitcnt lgkmcnt(6)
    v_max_f32 v248, v248, v250
    v_mov_b32 v249, v247
    v_mov_b32 v250, v248
    s_nop 0
    v_permlane32_swap_b32 v247, v249
    v_permlane32_swap_b32 v248, v250
    s_nop 0
    v_mfma_f32_16x16x32_bf16 v[176:179], v[72:75], v[112:115], v[176:179]
    ds_read_b64_tr_b16 v[60:61], v242 offset:8448
    ds_read_b64_tr_b16 v[62:63], v242 offset:9472
    v_max_f32 v247, v247, v249
    v_max_f32 v248, v248, v250
    v_add_f32 v247, 0x40e00000, v247
    v_add_f32 v248, 0x40e00000, v248
    v_sub_f32 v192, 0, v247
    v_sub_f32 v193, 0, v247
    v_sub_f32 v194, 0, v247
    v_mfma_f32_16x16x32_bf16 v[180:183], v[72:75], v[116:119], v[180:183]
    v_sub_f32 v195, 0, v247
    v_sub_f32 v196, 0, v248
    v_sub_f32 v197, 0, v248
    v_sub_f32 v198, 0, v248
    v_sub_f32 v199, 0, v248
    v_sub_f32 v80, v80, v247
    v_sub_f32 v81, v81, v247
    v_mfma_f32_16x16x32_bf16 v[184:187], v[76:79], v[112:115], v[184:187]
    ds_read_b64_tr_b16 v[64:65], v241 offset:8704
    ds_read_b64_tr_b16 v[66:67], v241 offset:9728
    v_sub_f32 v82, v82, v247
    v_sub_f32 v83, v83, v247
    v_sub_f32 v88, v88, v247
    v_sub_f32 v89, v89, v247
    v_sub_f32 v90, v90, v247
    v_sub_f32 v91, v91, v247
    v_sub_f32 v84, v84, v248
    v_mfma_f32_16x16x32_bf16 v[188:191], v[76:79], v[116:119], v[188:191]
    v_sub_f32 v85, v85, v248
    v_sub_f32 v86, v86, v248
    v_sub_f32 v87, v87, v248
    v_sub_f32 v92, v92, v248
    v_sub_f32 v93, v93, v248
    v_sub_f32 v94, v94, v248
    v_sub_f32 v95, v95, v248
    s_cbranch_vccnz L_slow_10
L_slow_10_ret:
    v_mfma_f32_16x16x32_bf16 v[200:203], v[208:211], v[120:123], v[200:203]
    v_exp_f32 v212, v80
    v_mfma_f32_16x16x32_bf16 v[204:207], v[208:211], v[124:127], v[204:207]
    s_waitcnt lgkmcnt(6)
    v_exp_f32 v213, v81
    v_mfma_f32_16x16x32_bf16 v[128:131], v[48:51], v[120:123], v[128:131]
    s_add_u32 s52, s52, 1
    ds_read_b64_tr_b16 v[68:69], v242 offset:8704
    ds_read_b64_tr_b16 v[70:71], v242 offset:9728
    v_mfma_f32_16x16x32_bf16 v[132:135], v[48:51], v[124:127], v[132:135]
    v_exp_f32 v214, v82
    v_mfma_f32_16x16x32_bf16 v[136:139], v[52:55], v[120:123], v[136:139]
    s_cmp_eq_u32 s52, 3
    ds_read_b64_tr_b16 v[72:73], v241 offset:8960
    ds_read_b64_tr_b16 v[74:75], v241 offset:9984
    v_mfma_f32_16x16x32_bf16 v[140:143], v[52:55], v[124:127], v[140:143]
    s_waitcnt lgkmcnt(6)
    v_cvt_pk_bf16_f32 v112, v212, v213
    v_exp_f32 v215, v83
    v_mfma_f32_16x16x32_bf16 v[144:147], v[56:59], v[120:123], v[144:147]
    s_cselect_b32 s53, s55, s54
    ds_read_b64_tr_b16 v[76:77], v242 offset:8960
    ds_read_b64_tr_b16 v[78:79], v242 offset:9984
    v_mfma_f32_16x16x32_bf16 v[148:151], v[56:59], v[124:127], v[148:151]
    v_exp_f32 v216, v88
    v_mfma_f32_16x16x32_bf16 v[152:155], v[60:63], v[120:123], v[152:155]
    s_cselect_b32 s52, 0, s52
    ds_read_b128 v[48:51], v240 offset:8192
    v_cvt_pk_bf16_f32 v113, v214, v215
    v_mfma_f32_16x16x32_bf16 v[156:159], v[60:63], v[124:127], v[156:159]
    s_waitcnt lgkmcnt(5)
    v_exp_f32 v217, v89
    v_mfma_f32_16x16x32_bf16 v[160:163], v[64:67], v[120:123], v[160:163]
    ds_read_b128 v[52:55], v240 offset:9216
    v_exp_f32 v218, v90
    v_mfma_f32_16x16x32_bf16 v[164:167], v[64:67], v[124:127], v[164:167]
    v_cvt_pk_bf16_f32 v114, v216, v217
    v_exp_f32 v219, v91
    v_mfma_f32_16x16x32_bf16 v[168:171], v[68:71], v[120:123], v[168:171]
    ds_read_b128 v[56:59], v240 offset:8448
    v_exp_f32 v212, v84
    v_mfma_f32_16x16x32_bf16 v[172:175], v[68:71], v[124:127], v[172:175]
    s_waitcnt lgkmcnt(3)
    v_cvt_pk_bf16_f32 v115, v218, v219
    v_exp_f32 v213, v85
    v_exp_f32 v214, v86
    v_cvt_pk_bf16_f32 v116, v212, v213
    v_mfma_f32_16x16x32_bf16 v[176:179], v[72:75], v[120:123], v[176:179]
    ds_read_b128 v[60:63], v240 offset:9472
    v_exp_f32 v215, v87
    v_exp_f32 v216, v92
    v_cvt_pk_bf16_f32 v117, v214, v215
    v_exp_f32 v217, v93
    v_exp_f32 v218, v94
    v_cvt_pk_bf16_f32 v118, v216, v217
    v_exp_f32 v219, v95
    v_mfma_f32_16x16x32_bf16 v[180:183], v[72:75], v[124:127], v[180:183]
    s_nop 0
    v_cvt_pk_bf16_f32 v119, v218, v219
    v_rcp_f32 v236, v200
    v_rcp_f32 v238, v204
    s_nop 0
    v_mov_b32 v237, v236
    v_mov_b32 v239, v238
    v_mfma_f32_16x16x32_bf16 v[184:187], v[76:79], v[120:123], v[184:187]
    ds_read_b128 v[64:67], v240 offset:8704
    v_mul_f32 v128, v236, v128
    v_mul_f32 v129, v236, v129
    v_mul_f32 v130, v236, v130
    v_mul_f32 v131, v236, v131
    v_mul_f32 v136, v236, v136
    v_mul_f32 v137, v236, v137
    v_mul_f32 v138, v236, v138
    v_mfma_f32_16x16x32_bf16 v[188:191], v[76:79], v[124:127], v[188:191]
    s_waitcnt lgkmcnt(3)
    v_mul_f32 v139, v236, v139
    v_mul_f32 v132, v238, v132
    v_mul_f32 v133, v238, v133
    v_mul_f32 v134, v238, v134
    v_mul_f32 v135, v238, v135
    v_mul_f32 v140, v238, v140
    v_mul_f32 v141, v238, v141
    v_mfma_f32_16x16x32_bf16 v[96:99], v[48:51], v[16:19], v[192:195]
    ds_read_b128 v[68:71], v240 offset:9728
    v_mul_f32 v142, v238, v142
    v_mul_f32 v143, v238, v143
    v_cvt_pk_bf16_f32 v220, v128, v129
    v_cvt_pk_bf16_f32 v221, v130, v131
    v_cvt_pk_bf16_f32 v222, v136, v137
    v_cvt_pk_bf16_f32 v223, v138, v139
    v_cvt_pk_bf16_f32 v224, v132, v133
    v_mfma_f32_16x16x32_bf16 v[100:103], v[48:51], v[32:35], v[196:199]
    v_cvt_pk_bf16_f32 v225, v134, v135
    v_cvt_pk_bf16_f32 v226, v140, v141
    v_cvt_pk_bf16_f32 v227, v142, v143
    v_permlane16_swap_b32 v220, v222
    v_permlane16_swap_b32 v221, v223
    v_permlane16_swap_b32 v224, v226
    v_permlane16_swap_b32 v225, v227
    v_mfma_f32_16x16x32_bf16 v[104:107], v[52:55], v[16:19], v[192:195]
    ds_read_b128 v[72:75], v240 offset:8960
    ds_write_b128 v244, v[220:223] offset:0
    ds_write_b128 v244, v[224:227] offset:2048
    v_mov_b64 v[128:129], 0
    v_mov_b64 v[130:131], 0
    v_mov_b64 v[132:133], 0
    v_mov_b64 v[134:135], 0
    v_mov_b64 v[136:137], 0
    v_mfma_f32_16x16x32_bf16 v[108:111], v[52:55], v[32:35], v[196:199]
    s_waitcnt lgkmcnt(5)
    v_mov_b64 v[138:139], 0
    v_mov_b64 v[140:141], 0
    v_mov_b64 v[142:143], 0
    v_mul_f32 v144, v236, v144
    v_mul_f32 v145, v236, v145
    v_mul_f32 v146, v236, v146
    v_mul_f32 v147, v236, v147
    v_mfma_f32_16x16x32_bf16 v[96:99], v[56:59], v[20:23], v[96:99]
    ds_read_b128 v[76:79], v240 offset:9984
    v_mul_f32 v152, v236, v152
    v_mul_f32 v153, v236, v153
    v_mul_f32 v154, v236, v154
    v_mul_f32 v155, v236, v155
    v_mul_f32 v148, v238, v148
    v_mul_f32 v149, v238, v149
    v_mul_f32 v150, v238, v150
    v_mfma_f32_16x16x32_bf16 v[100:103], v[56:59], v[36:39], v[100:103]
    v_add_u32 v240, s53, v240
    v_mul_f32 v151, v238, v151
    v_mul_f32 v156, v238, v156
    v_mul_f32 v157, v238, v157
    v_mul_f32 v158, v238, v158
    v_mul_f32 v159, v238, v159
    v_cvt_pk_bf16_f32 v228, v144, v145
    v_cvt_pk_bf16_f32 v229, v146, v147
    v_mfma_f32_16x16x32_bf16 v[104:107], v[60:63], v[20:23], v[104:107]
    s_barrier
    ds_read_b128 v[48:51], v240 offset:0
    v_cvt_pk_bf16_f32 v230, v152, v153
    v_cvt_pk_bf16_f32 v231, v154, v155
    v_cvt_pk_bf16_f32 v232, v148, v149
    v_cvt_pk_bf16_f32 v233, v150, v151
    v_cvt_pk_bf16_f32 v234, v156, v157
    v_cvt_pk_bf16_f32 v235, v158, v159
    v_permlane16_swap_b32 v228, v230
    v_mfma_f32_16x16x32_bf16 v[108:111], v[60:63], v[36:39], v[108:111]
    s_waitcnt lgkmcnt(5)
    v_permlane16_swap_b32 v229, v231
    v_permlane16_swap_b32 v232, v234
    v_permlane16_swap_b32 v233, v235
    ds_write_b128 v244, v[228:231] offset:1024
    ds_write_b128 v244, v[232:235] offset:3072
    v_mov_b64 v[144:145], 0
    v_mov_b64 v[146:147], 0
    v_mfma_f32_16x16x32_bf16 v[96:99], v[64:67], v[24:27], v[96:99]
    ds_read_b128 v[52:55], v240 offset:1024
    v_mov_b64 v[148:149], 0
    v_mov_b64 v[150:151], 0
    v_mov_b64 v[152:153], 0
    v_mov_b64 v[154:155], 0
    v_mov_b64 v[156:157], 0
    v_mov_b64 v[158:159], 0
    v_mul_f32 v160, v236, v160
    v_mfma_f32_16x16x32_bf16 v[100:103], v[64:67], v[40:43], v[100:103]
    v_mul_f32 v161, v236, v161
    v_mul_f32 v162, v236, v162
    v_mul_f32 v163, v236, v163
    v_mul_f32 v168, v236, v168
    v_mul_f32 v169, v236, v169
    v_mul_f32 v170, v236, v170
    v_mul_f32 v171, v236, v171
    v_mfma_f32_16x16x32_bf16 v[104:107], v[68:71], v[24:27], v[104:107]
    ds_read_b128 v[56:59], v240 offset:256
    v_mul_f32 v164, v238, v164
    v_mul_f32 v165, v238, v165
    v_mul_f32 v166, v238, v166
    v_mul_f32 v167, v238, v167
    v_mul_f32 v172, v238, v172
    v_mul_f32 v173, v238, v173
    v_mul_f32 v174, v238, v174
    v_mfma_f32_16x16x32_bf16 v[108:111], v[68:71], v[40:43], v[108:111]
    s_waitcnt lgkmcnt(5)
    v_mul_f32 v175, v238, v175
    v_cvt_pk_bf16_f32 v220, v160, v161
    v_cvt_pk_bf16_f32 v221, v162, v163
    v_cvt_pk_bf16_f32 v222, v168, v169
    v_cvt_pk_bf16_f32 v223, v170, v171
    v_cvt_pk_bf16_f32 v224, v164, v165
    v_cvt_pk_bf16_f32 v225, v166, v167
    v_mfma_f32_16x16x32_bf16 v[96:99], v[72:75], v[28:31], v[96:99]
    ds_read_b128 v[60:63], v240 offset:1280
    v_cvt_pk_bf16_f32 v226, v172, v173
    v_cvt_pk_bf16_f32 v227, v174, v175
    v_permlane16_swap_b32 v220, v222
    v_permlane16_swap_b32 v221, v223
    v_permlane16_swap_b32 v224, v226
    v_permlane16_swap_b32 v225, v227
    ds_write_b128 v244, v[220:223] offset:16384
    v_mfma_f32_16x16x32_bf16 v[100:103], v[72:75], v[44:47], v[100:103]
    ds_write_b128 v244, v[224:227] offset:18432
    v_mov_b64 v[160:161], 0
    v_mov_b64 v[162:163], 0
    v_mov_b64 v[164:165], 0
    v_mov_b64 v[166:167], 0
    v_mov_b64 v[168:169], 0
    v_mov_b64 v[170:171], 0
    v_mfma_f32_16x16x32_bf16 v[104:107], v[76:79], v[28:31], v[104:107]
    ds_read_b128 v[64:67], v240 offset:512
    v_mov_b64 v[172:173], 0
    v_mov_b64 v[174:175], 0
    v_mul_f32 v176, v236, v176
    v_mul_f32 v177, v236, v177
    v_mul_f32 v178, v236, v178
    v_mul_f32 v179, v236, v179
    v_mul_f32 v184, v236, v184
    v_mfma_f32_16x16x32_bf16 v[108:111], v[76:79], v[44:47], v[108:111]
    v_mul_f32 v185, v236, v185
    v_mul_f32 v186, v236, v186
    v_mul_f32 v187, v236, v187
    v_mul_f32 v180, v238, v180
    v_mul_f32 v181, v238, v181
    v_mul_f32 v182, v238, v182
    v_mul_f32 v183, v238, v183
    v_mul_f32 v188, v238, v188
    v_mul_f32 v189, v238, v189
    v_mul_f32 v190, v238, v190
    v_mul_f32 v191, v238, v191
    v_cvt_pk_bf16_f32 v228, v176, v177
    v_cvt_pk_bf16_f32 v229, v178, v179
    v_cvt_pk_bf16_f32 v230, v184, v185
    v_cvt_pk_bf16_f32 v231, v186, v187
    v_cvt_pk_bf16_f32 v232, v180, v181
    v_cvt_pk_bf16_f32 v233, v182, v183
    v_cvt_pk_bf16_f32 v234, v188, v189
    v_cvt_pk_bf16_f32 v235, v190, v191
    v_permlane16_swap_b32 v228, v230
    v_permlane16_swap_b32 v229, v231
    v_permlane16_swap_b32 v232, v234
    v_permlane16_swap_b32 v233, v235
    ds_write_b128 v244, v[228:231] offset:17408
    ds_write_b128 v244, v[232:235] offset:19456
    v_mov_b64 v[176:177], 0
    v_mov_b64 v[178:179], 0
    v_mov_b64 v[180:181], 0
    v_mov_b64 v[182:183], 0
    v_mov_b64 v[184:185], 0
    v_mov_b64 v[186:187], 0
    v_mov_b64 v[188:189], 0
    v_mov_b64 v[190:191], 0
    v_mov_b64 v[200:201], 0
    v_mov_b64 v[202:203], 0
    v_mov_b64 v[204:205], 0
    v_mov_b64 v[206:207], 0
    s_waitcnt lgkmcnt(0)
    s_branch L_aloop
L_atail:
    s_waitcnt lgkmcnt(0)
    s_barrier
    ds_read_b64_tr_b16 v[48:49], v241 offset:0
    ds_read_b64_tr_b16 v[50:51], v241 offset:1024
    ds_read_b64_tr_b16 v[52:53], v242 offset:0
    ds_read_b64_tr_b16 v[54:55], v242 offset:1024
    ds_read_b64_tr_b16 v[56:57], v241 offset:256
    ds_read_b64_tr_b16 v[58:59], v241 offset:1280
    ds_read_b64_tr_b16 v[60:61], v242 offset:256
    ds_read_b64_tr_b16 v[62:63], v242 offset:1280
    ds_read_b64_tr_b16 v[64:65], v241 offset:512
    ds_read_b64_tr_b16 v[66:67], v241 offset:1536
    v_exp_f32 v212, v96
    v_exp_f32 v213, v97
    v_exp_f32 v214, v98
    v_cvt_pk_bf16_f32 v120, v212, v213
    v_exp_f32 v215, v99
    v_exp_f32 v216, v104
    v_cvt_pk_bf16_f32 v121, v214, v215
    v_exp_f32 v217, v105
    v_exp_f32 v218, v106
    v_cvt_pk_bf16_f32 v122, v216, v217
    v_mfma_f32_16x16x32_bf16 v[200:203], v[208:211], v[112:115], v[200:203]
    v_exp_f32 v219, v107
    v_mfma_f32_16x16x32_bf16 v[204:207], v[208:211], v[116:119], v[204:207]
    s_waitcnt lgkmcnt(6)
    v_exp_f32 v212, v100
    v_mfma_f32_16x16x32_bf16 v[128:131], v[48:51], v[112:115], v[128:131]
    ds_read_b64_tr_b16 v[68:69], v242 offset:512
    ds_read_b64_tr_b16 v[70:71], v242 offset:1536
    v_mfma_f32_16x16x32_bf16 v[132:135], v[48:51], v[116:119], v[132:135]
    v_cvt_pk_bf16_f32 v123, v218, v219
    v_exp_f32 v213, v101
    v_mfma_f32_16x16x32_bf16 v[136:139], v[52:55], v[112:115], v[136:139]
    ds_read_b64_tr_b16 v[72:73], v241 offset:768
    ds_read_b64_tr_b16 v[74:75], v241 offset:1792
    v_mfma_f32_16x16x32_bf16 v[140:143], v[52:55], v[116:119], v[140:143]
    s_waitcnt lgkmcnt(6)
    v_or3_b32 v246, v120, v121, v122
    v_exp_f32 v214, v102
    v_mfma_f32_16x16x32_bf16 v[144:147], v[56:59], v[112:115], v[144:147]
    ds_read_b64_tr_b16 v[76:77], v242 offset:768
    ds_read_b64_tr_b16 v[78:79], v242 offset:1792
    v_mfma_f32_16x16x32_bf16 v[148:151], v[56:59], v[116:119], v[148:151]
    v_cvt_pk_bf16_f32 v124, v212, v213
    v_exp_f32 v215, v103
    v_mfma_f32_16x16x32_bf16 v[152:155], v[60:63], v[112:115], v[152:155]
    ds_read_b64_tr_b16 v[48:49], v241 offset:8192
    ds_read_b64_tr_b16 v[50:51], v241 offset:9216
    v_mfma_f32_16x16x32_bf16 v[156:159], v[60:63], v[116:119], v[156:159]
    s_waitcnt lgkmcnt(6)
    v_exp_f32 v216, v108
    v_mfma_f32_16x16x32_bf16 v[160:163], v[64:67], v[112:115], v[160:163]
    ds_read_b64_tr_b16 v[52:53], v242 offset:8192
    ds_read_b64_tr_b16 v[54:55], v242 offset:9216
    v_mfma_f32_16x16x32_bf16 v[164:167], v[64:67], v[116:119], v[164:167]
    v_cvt_pk_bf16_f32 v125, v214, v215
    v_exp_f32 v217, v109
    v_mfma_f32_16x16x32_bf16 v[168:171], v[68:71], v[112:115], v[168:171]
    ds_read_b64_tr_b16 v[56:57], v241 offset:8448
    ds_read_b64_tr_b16 v[58:59], v241 offset:9472
    v_mfma_f32_16x16x32_bf16 v[172:175], v[68:71], v[116:119], v[172:175]
    s_waitcnt lgkmcnt(6)
    v_or3_b32 v246, v246, v123, v124
    v_exp_f32 v218, v110
    v_mfma_f32_16x16x32_bf16 v[176:179], v[72:75], v[112:115], v[176:179]
    ds_read_b64_tr_b16 v[60:61], v242 offset:8448
    ds_read_b64_tr_b16 v[62:63], v242 offset:9472
    v_mfma_f32_16x16x32_bf16 v[180:183], v[72:75], v[116:119], v[180:183]
    v_cvt_pk_bf16_f32 v126, v216, v217
    v_exp_f32 v219, v111
    v_mfma_f32_16x16x32_bf16 v[184:187], v[76:79], v[112:115], v[184:187]
    ds_read_b64_tr_b16 v[64:65], v241 offset:8704
    ds_read_b64_tr_b16 v[66:67], v241 offset:9728
    v_or3_b32 v246, v246, v125, v126
    v_mfma_f32_16x16x32_bf16 v[188:191], v[76:79], v[116:119], v[188:191]
    v_cvt_pk_bf16_f32 v127, v218, v219
    v_bitop3_b32 v246, v246, v127, s65 bitop3:0xa8
    v_cmp_ne_u32 vcc, 0, v246
    s_cbranch_vccnz L_slow_11
L_slow_11_ret:
    s_nop 0
    v_mfma_f32_16x16x32_bf16 v[200:203], v[208:211], v[120:123], v[200:203]
    v_mfma_f32_16x16x32_bf16 v[204:207], v[208:211], v[124:127], v[204:207]
    s_waitcnt lgkmcnt(6)
    v_mfma_f32_16x16x32_bf16 v[128:131], v[48:51], v[120:123], v[128:131]
    ds_read_b64_tr_b16 v[68:69], v242 offset:8704
    ds_read_b64_tr_b16 v[70:71], v242 offset:9728
    v_mfma_f32_16x16x32_bf16 v[132:135], v[48:51], v[124:127], v[132:135]
    v_mfma_f32_16x16x32_bf16 v[136:139], v[52:55], v[120:123], v[136:139]
    ds_read_b64_tr_b16 v[72:73], v241 offset:8960
    ds_read_b64_tr_b16 v[74:75], v241 offset:9984
    v_mfma_f32_16x16x32_bf16 v[140:143], v[52:55], v[124:127], v[140:143]
    s_waitcnt lgkmcnt(6)
    v_mfma_f32_16x16x32_bf16 v[144:147], v[56:59], v[120:123], v[144:147]
    ds_read_b64_tr_b16 v[76:77], v242 offset:8960
    ds_read_b64_tr_b16 v[78:79], v242 offset:9984
    v_mfma_f32_16x16x32_bf16 v[148:151], v[56:59], v[124:127], v[148:151]
    v_rcp_f32 v236, v200
    v_mfma_f32_16x16x32_bf16 v[152:155], v[60:63], v[120:123], v[152:155]
    v_rcp_f32 v238, v204
    v_mfma_f32_16x16x32_bf16 v[156:159], v[60:63], v[124:127], v[156:159]
    s_waitcnt lgkmcnt(4)
    s_nop 0
    v_mov_b32 v237, v236
    v_mfma_f32_16x16x32_bf16 v[160:163], v[64:67], v[120:123], v[160:163]
    v_mov_b32 v239, v238
    v_mul_f32 v128, v236, v128
    v_mfma_f32_16x16x32_bf16 v[164:167], v[64:67], v[124:127], v[164:167]
    v_mul_f32 v129, v236, v129
    v_mul_f32 v130, v236, v130
    v_mfma_f32_16x16x32_bf16 v[168:171], v[68:71], v[120:123], v[168:171]
    v_mul_f32 v131, v236, v131
    v_mul_f32 v136, v236, v136
    v_mfma_f32_16x16x32_bf16 v[172:175], v[68:71], v[124:127], v[172:175]
    s_waitcnt lgkmcnt(0)
    v_mul_f32 v137, v236, v137
    v_mul_f32 v138, v236, v138
    v_mfma_f32_16x16x32_bf16 v[176:179], v[72:75], v[120:123], v[176:179]
    v_mul_f32 v139, v236, v139
    v_mul_f32 v132, v238, v132
    v_mfma_f32_16x16x32_bf16 v[180:183], v[72:75], v[124:127], v[180:183]
    v_mul_f32 v133, v238, v133
    v_mul_f32 v134, v238, v134
    v_mul_f32 v135, v238, v135
    v_mul_f32 v140, v238, v140
    v_mul_f32 v141, v238, v141
    v_mul_f32 v142, v238, v142
    v_mul_f32 v143, v238, v143
    v_mfma_f32_16x16x32_bf16 v[184:187], v[76:79], v[120:123], v[184:187]
    v_cvt_pk_bf16_f32 v220, v128, v129
    v_cvt_pk_bf16_f32 v221, v130, v131
    v_cvt_pk_bf16_f32 v222, v136, v137
    v_cvt_pk_bf16_f32 v223, v138, v139
    v_cvt_pk_bf16_f32 v224, v132, v133
    v_cvt_pk_bf16_f32 v225, v134, v135
    v_cvt_pk_bf16_f32 v226, v140, v141
    v_mfma_f32_16x16x32_bf16 v[188:191], v[76:79], v[124:127], v[188:191]
    v_cvt_pk_bf16_f32 v227, v142, v143
    v_permlane16_swap_b32 v220, v222
    v_permlane16_swap_b32 v221, v223
    v_permlane16_swap_b32 v224, v226
    v_permlane16_swap_b32 v225, v227
    ds_write_b128 v244, v[220:223] offset:16384
    ds_write_b128 v244, v[224:227] offset:18432
    v_pk_mul_f32 v[144:145], v[144:145], v[236:237]
    v_pk_mul_f32 v[146:147], v[146:147], v[236:237]
    v_pk_mul_f32 v[152:153], v[152:153], v[236:237]
    v_pk_mul_f32 v[154:155], v[154:155], v[236:237]
    v_pk_mul_f32 v[148:149], v[148:149], v[238:239]
    v_pk_mul_f32 v[150:151], v[150:151], v[238:239]
    v_pk_mul_f32 v[156:157], v[156:157], v[238:239]
    v_pk_mul_f32 v[158:159], v[158:159], v[238:239]
    v_cvt_pk_bf16_f32 v228, v144, v145
    v_cvt_pk_bf16_f32 v229, v146, v147
    v_cvt_pk_bf16_f32 v230, v152, v153
    v_cvt_pk_bf16_f32 v231, v154, v155
    v_cvt_pk_bf16_f32 v232, v148, v149
    v_cvt_pk_bf16_f32 v233, v150, v151
    v_cvt_pk_bf16_f32 v234, v156, v157
    v_cvt_pk_bf16_f32 v235, v158, v159
    v_permlane16_swap_b32 v228, v230
    v_permlane16_swap_b32 v229, v231
    v_permlane16_swap_b32 v232, v234
    v_permlane16_swap_b32 v233, v235
    ds_write_b128 v244, v[228:231] offset:17408
    ds_write_b128 v244, v[232:235] offset:19456
    v_pk_mul_f32 v[160:161], v[160:161], v[236:237]
    v_pk_mul_f32 v[162:163], v[162:163], v[236:237]
    v_pk_mul_f32 v[168:169], v[168:169], v[236:237]
    v_pk_mul_f32 v[170:171], v[170:171], v[236:237]
    v_pk_mul_f32 v[164:165], v[164:165], v[238:239]
    v_pk_mul_f32 v[166:167], v[166:167], v[238:239]
    v_pk_mul_f32 v[172:173], v[172:173], v[238:239]
    v_pk_mul_f32 v[174:175], v[174:175], v[238:239]
    v_cvt_pk_bf16_f32 v220, v160, v161
    v_cvt_pk_bf16_f32 v221, v162, v163
    v_cvt_pk_bf16_f32 v222, v168, v169
    v_cvt_pk_bf16_f32 v223, v170, v171
    v_cvt_pk_bf16_f32 v224, v164, v165
    v_cvt_pk_bf16_f32 v225, v166, v167
    v_cvt_pk_bf16_f32 v226, v172, v173
    v_cvt_pk_bf16_f32 v227, v174, v175
    v_permlane16_swap_b32 v220, v222
    v_permlane16_swap_b32 v221, v223
    v_permlane16_swap_b32 v224, v226
    v_permlane16_swap_b32 v225, v227
    ds_write_b128 v245, v[220:223] offset:0
    ds_write_b128 v245, v[224:227] offset:2048
    v_pk_mul_f32 v[176:177], v[176:177], v[236:237]
    v_pk_mul_f32 v[178:179], v[178:179], v[236:237]
    v_pk_mul_f32 v[184:185], v[184:185], v[236:237]
    v_pk_mul_f32 v[186:187], v[186:187], v[236:237]
    v_pk_mul_f32 v[180:181], v[180:181], v[238:239]
    v_pk_mul_f32 v[182:183], v[182:183], v[238:239]
    v_pk_mul_f32 v[188:189], v[188:189], v[238:239]
    v_pk_mul_f32 v[190:191], v[190:191], v[238:239]
    v_cvt_pk_bf16_f32 v228, v176, v177
    v_cvt_pk_bf16_f32 v229, v178, v179
    v_cvt_pk_bf16_f32 v230, v184, v185
    v_cvt_pk_bf16_f32 v231, v186, v187
    v_cvt_pk_bf16_f32 v232, v180, v181
    v_cvt_pk_bf16_f32 v233, v182, v183
    v_cvt_pk_bf16_f32 v234, v188, v189
    v_cvt_pk_bf16_f32 v235, v190, v191
    v_permlane16_swap_b32 v228, v230
    v_permlane16_swap_b32 v229, v231
    v_permlane16_swap_b32 v232, v234
    v_permlane16_swap_b32 v233, v235
    ds_write_b128 v245, v[228:231] offset:1024
    ds_write_b128 v245, v[232:235] offset:3072
    s_mov_b32 s56, 1
    s_mov_b32 s57, 13
    s_mov_b32 s52, 2
    s_mov_b32 s54, -49152
    s_mov_b32 s55, 98304
    s_waitcnt lgkmcnt(0)
    s_branch L_gemm
L_oepi:
    v_mfma_f32_16x16x32_bf16 v[128:131], v[48:51], v[16:19], v[128:131]
    s_xor_b32 s3, s60, 4
    v_mfma_f32_16x16x32_bf16 v[132:135], v[48:51], v[20:23], v[132:135]
    s_mul_i32 s3, s3, 49152
    v_mfma_f32_16x16x32_bf16 v[136:139], v[48:51], v[24:27], v[136:139]
    s_lshl_b32 s61, s46, 12
    v_mfma_f32_16x16x32_bf16 v[140:143], v[48:51], v[28:31], v[140:143]
    s_add_u32 s61, s61, s3
    v_mfma_f32_16x16x32_bf16 v[144:147], v[52:55], v[16:19], v[144:147]
    s_add_u32 s61, s61, 16777216
    v_mfma_f32_16x16x32_bf16 v[148:151], v[52:55], v[20:23], v[148:151]
    s_waitcnt lgkmcnt(0)
    v_mfma_f32_16x16x32_bf16 v[152:155], v[52:55], v[24:27], v[152:155]
    ds_read_b128 v[32:35], v5 offset:0
    v_mfma_f32_16x16x32_bf16 v[156:159], v[52:55], v[28:31], v[156:159]
    ds_read_b128 v[36:39], v5 offset:2048
    v_mfma_f32_16x16x32_bf16 v[160:163], v[56:59], v[16:19], v[160:163]
    ds_read_b128 v[40:43], v5 offset:4096
    v_mfma_f32_16x16x32_bf16 v[164:167], v[56:59], v[20:23], v[164:167]
    ds_read_b128 v[44:47], v5 offset:6144
    v_mfma_f32_16x16x32_bf16 v[168:171], v[56:59], v[24:27], v[168:171]
    v_add_u32 v4, -98304, v4
    v_mfma_f32_16x16x32_bf16 v[172:175], v[56:59], v[28:31], v[172:175]
    v_add_u32 v5, -98304, v5
    v_mfma_f32_16x16x32_bf16 v[176:179], v[60:63], v[16:19], v[176:179]
    s_barrier
    v_mfma_f32_16x16x32_bf16 v[180:183], v[60:63], v[20:23], v[180:183]
    ds_read_b128 v[80:83], v4 offset:49152
    v_add_u32 v14, -98304, v8
    v_mfma_f32_16x16x32_bf16 v[184:187], v[60:63], v[24:27], v[184:187]
    ds_read_b128 v[84:87], v4 offset:51200
    v_add_u32 v15, -98304, v9
    v_mfma_f32_16x16x32_bf16 v[188:191], v[60:63], v[28:31], v[188:191]
    ds_read_b128 v[88:91], v4 offset:53248
    v_mfma_f32_16x16x32_bf16 v[192:195], v[64:67], v[16:19], v[192:195]
    ds_read_b128 v[92:95], v4 offset:55296
    v_mfma_f32_16x16x32_bf16 v[196:199], v[64:67], v[20:23], v[196:199]
    ds_read_b128 v[96:99], v5 offset:49152
    v_mfma_f32_16x16x32_bf16 v[200:203], v[64:67], v[24:27], v[200:203]
    ds_read_b128 v[100:103], v5 offset:51200
    v_mfma_f32_16x16x32_bf16 v[204:207], v[64:67], v[28:31], v[204:207]
    ds_read_b128 v[104:107], v5 offset:53248
    v_mfma_f32_16x16x32_bf16 v[208:211], v[68:71], v[16:19], v[208:211]
    ds_read_b128 v[108:111], v5 offset:55296
    v_mfma_f32_16x16x32_bf16 v[212:215], v[68:71], v[20:23], v[212:215]
    ds_read_b64_tr_b16 v[112:113], v8 offset:8192
    v_mfma_f32_16x16x32_bf16 v[216:219], v[68:71], v[24:27], v[216:219]
    ds_read_b64_tr_b16 v[114:115], v8 offset:9216
    v_mfma_f32_16x16x32_bf16 v[220:223], v[68:71], v[28:31], v[220:223]
    ds_read_b64_tr_b16 v[116:117], v9 offset:8192
    v_mfma_f32_16x16x32_bf16 v[224:227], v[72:75], v[16:19], v[224:227]
    ds_read_b64_tr_b16 v[118:119], v9 offset:9216
    v_mfma_f32_16x16x32_bf16 v[228:231], v[72:75], v[20:23], v[228:231]
    ds_read_b64_tr_b16 v[120:121], v14 offset:49152
    v_mfma_f32_16x16x32_bf16 v[232:235], v[72:75], v[24:27], v[232:235]
    ds_read_b64_tr_b16 v[122:123], v14 offset:50176
    v_mfma_f32_16x16x32_bf16 v[236:239], v[72:75], v[28:31], v[236:239]
    ds_read_b64_tr_b16 v[124:125], v15 offset:49152
    v_mfma_f32_16x16x32_bf16 v[240:243], v[76:79], v[16:19], v[240:243]
    ds_read_b64_tr_b16 v[126:127], v15 offset:50176
    v_mfma_f32_16x16x32_bf16 v[244:247], v[76:79], v[20:23], v[244:247]
    v_mfma_f32_16x16x32_bf16 v[248:251], v[76:79], v[24:27], v[248:251]
    v_mfma_f32_16x16x32_bf16 v[252:255], v[76:79], v[28:31], v[252:255]
    s_waitcnt lgkmcnt(4)
    v_mfma_f32_16x16x32_bf16 v[160:163], v[112:115], v[32:35], v[160:163]
    s_barrier
    v_mfma_f32_16x16x32_bf16 v[164:167], v[112:115], v[36:39], v[164:167]
    ds_read_b128 v[16:19], v4 offset:0
    v_mfma_f32_16x16x32_bf16 v[168:171], v[112:115], v[40:43], v[168:171]
    ds_read_b128 v[20:23], v4 offset:2048
    v_mfma_f32_16x16x32_bf16 v[172:175], v[112:115], v[44:47], v[172:175]
    ds_read_b128 v[24:27], v4 offset:4096
    v_mfma_f32_16x16x32_bf16 v[176:179], v[116:119], v[32:35], v[176:179]
    ds_read_b128 v[28:31], v4 offset:6144
    v_mfma_f32_16x16x32_bf16 v[180:183], v[116:119], v[36:39], v[180:183]
    ds_read_b64_tr_b16 v[64:65], v14 offset:57344
    v_mfma_f32_16x16x32_bf16 v[184:187], v[116:119], v[40:43], v[184:187]
    ds_read_b64_tr_b16 v[66:67], v14 offset:58368
    v_mfma_f32_16x16x32_bf16 v[188:191], v[116:119], v[44:47], v[188:191]
    s_waitcnt lgkmcnt(6)
    ds_read_b64_tr_b16 v[68:69], v15 offset:57344
    ds_read_b64_tr_b16 v[70:71], v15 offset:58368
    v_mfma_f32_16x16x32_bf16 v[160:163], v[120:123], v[80:83], v[160:163]
    ds_read_b128 v[48:51], v5 offset:0
    v_mfma_f32_16x16x32_bf16 v[164:167], v[120:123], v[84:87], v[164:167]
    ds_read_b128 v[52:55], v5 offset:2048
    v_mfma_f32_16x16x32_bf16 v[168:171], v[120:123], v[88:91], v[168:171]
    ds_read_b128 v[56:59], v5 offset:4096
    v_mfma_f32_16x16x32_bf16 v[172:175], v[120:123], v[92:95], v[172:175]
    ds_read_b128 v[60:63], v5 offset:6144
    v_mfma_f32_16x16x32_bf16 v[176:179], v[124:127], v[80:83], v[176:179]
    ds_read_b64_tr_b16 v[72:73], v14 offset:0
    v_mfma_f32_16x16x32_bf16 v[180:183], v[124:127], v[84:87], v[180:183]
    ds_read_b64_tr_b16 v[74:75], v14 offset:1024
    v_mfma_f32_16x16x32_bf16 v[184:187], v[124:127], v[88:91], v[184:187]
    ds_read_b64_tr_b16 v[76:77], v15 offset:0
    v_mfma_f32_16x16x32_bf16 v[188:191], v[124:127], v[92:95], v[188:191]
    s_waitcnt lgkmcnt(7)
    ds_read_b64_tr_b16 v[78:79], v15 offset:1024
    v_mfma_f32_16x16x32_bf16 v[160:163], v[64:67], v[96:99], v[160:163]
    v_mfma_f32_16x16x32_bf16 v[164:167], v[64:67], v[100:103], v[164:167]
    v_mfma_f32_16x16x32_bf16 v[168:171], v[64:67], v[104:107], v[168:171]
    ds_read_b64_tr_b16 v[112:113], v14 offset:8192
    v_mfma_f32_16x16x32_bf16 v[172:175], v[64:67], v[108:111], v[172:175]
    ds_read_b64_tr_b16 v[114:115], v14 offset:9216
    v_mfma_f32_16x16x32_bf16 v[176:179], v[68:71], v[96:99], v[176:179]
    ds_read_b64_tr_b16 v[116:117], v15 offset:8192
    v_mfma_f32_16x16x32_bf16 v[180:183], v[68:71], v[100:103], v[180:183]
    ds_read_b64_tr_b16 v[118:119], v15 offset:9216
    v_mfma_f32_16x16x32_bf16 v[184:187], v[68:71], v[104:107], v[184:187]
    v_mfma_f32_16x16x32_bf16 v[188:191], v[68:71], v[108:111], v[188:191]
    s_waitcnt lgkmcnt(4)
    v_mfma_f32_16x16x32_bf16 v[160:163], v[72:75], v[16:19], v[160:163]
    v_mfma_f32_16x16x32_bf16 v[164:167], v[72:75], v[20:23], v[164:167]
    v_mfma_f32_16x16x32_bf16 v[168:171], v[72:75], v[24:27], v[168:171]
    ds_read_b64_tr_b16 v[120:121], v10 offset:8192
    v_mfma_f32_16x16x32_bf16 v[172:175], v[72:75], v[28:31], v[172:175]
    ds_read_b64_tr_b16 v[122:123], v10 offset:9216
    v_mfma_f32_16x16x32_bf16 v[176:179], v[76:79], v[16:19], v[176:179]
    ds_read_b64_tr_b16 v[124:125], v11 offset:8192
    v_mfma_f32_16x16x32_bf16 v[180:183], v[76:79], v[20:23], v[180:183]
    ds_read_b64_tr_b16 v[126:127], v11 offset:9216
    v_mfma_f32_16x16x32_bf16 v[184:187], v[76:79], v[24:27], v[184:187]
    v_mfma_f32_16x16x32_bf16 v[188:191], v[76:79], v[28:31], v[188:191]
    s_waitcnt lgkmcnt(4)
    v_mfma_f32_16x16x32_bf16 v[160:163], v[112:115], v[48:51], v[160:163]
    v_add_u32 v14, -98304, v10
    v_mfma_f32_16x16x32_bf16 v[164:167], v[112:115], v[52:55], v[164:167]
    v_add_u32 v15, -98304, v11
    v_mfma_f32_16x16x32_bf16 v[168:171], v[112:115], v[56:59], v[168:171]
    ds_read_b64_tr_b16 v[64:65], v14 offset:49152
    v_mfma_f32_16x16x32_bf16 v[172:175], v[112:115], v[60:63], v[172:175]
    ds_read_b64_tr_b16 v[66:67], v14 offset:50176
    v_mfma_f32_16x16x32_bf16 v[176:179], v[116:119], v[48:51], v[176:179]
    ds_read_b64_tr_b16 v[68:69], v15 offset:49152
    v_mfma_f32_16x16x32_bf16 v[180:183], v[116:119], v[52:55], v[180:183]
    ds_read_b64_tr_b16 v[70:71], v15 offset:50176
    v_mfma_f32_16x16x32_bf16 v[184:187], v[116:119], v[56:59], v[184:187]
    v_mfma_f32_16x16x32_bf16 v[188:191], v[116:119], v[60:63], v[188:191]
    s_waitcnt lgkmcnt(4)
    v_mfma_f32_16x16x32_bf16 v[192:195], v[120:123], v[32:35], v[192:195]
    v_mfma_f32_16x16x32_bf16 v[196:199], v[120:123], v[36:39], v[196:199]
    v_mfma_f32_16x16x32_bf16 v[200:203], v[120:123], v[40:43], v[200:203]
    ds_read_b64_tr_b16 v[72:73], v14 offset:57344
    v_mfma_f32_16x16x32_bf16 v[204:207], v[120:123], v[44:47], v[204:207]
    ds_read_b64_tr_b16 v[74:75], v14 offset:58368
    v_cvt_pk_bf16_f32 v160, v160, v161
    v_mfma_f32_16x16x32_bf16 v[208:211], v[124:127], v[32:35], v[208:211]
    ds_read_b64_tr_b16 v[76:77], v15 offset:57344
    v_cvt_pk_bf16_f32 v161, v162, v163
    v_mfma_f32_16x16x32_bf16 v[212:215], v[124:127], v[36:39], v[212:215]
    ds_read_b64_tr_b16 v[78:79], v15 offset:58368
    v_cvt_pk_bf16_f32 v162, v176, v177
    v_mfma_f32_16x16x32_bf16 v[216:219], v[124:127], v[40:43], v[216:219]
    v_cvt_pk_bf16_f32 v163, v178, v179
    v_mfma_f32_16x16x32_bf16 v[220:223], v[124:127], v[44:47], v[220:223]
    s_waitcnt lgkmcnt(4)
    buffer_store_dwordx4 v[160:163], v3, s[32:35], s61 offen offset:0 sc1
    v_mfma_f32_16x16x32_bf16 v[192:195], v[64:67], v[80:83], v[192:195]
    v_cvt_pk_bf16_f32 v164, v164, v165
    v_mfma_f32_16x16x32_bf16 v[196:199], v[64:67], v[84:87], v[196:199]
    v_cvt_pk_bf16_f32 v165, v166, v167
    v_mfma_f32_16x16x32_bf16 v[200:203], v[64:67], v[88:91], v[200:203]
    ds_read_b64_tr_b16 v[112:113], v14 offset:0
    v_cvt_pk_bf16_f32 v166, v180, v181
    v_mfma_f32_16x16x32_bf16 v[204:207], v[64:67], v[92:95], v[204:207]
    ds_read_b64_tr_b16 v[114:115], v14 offset:1024
    v_cvt_pk_bf16_f32 v167, v182, v183
    v_mfma_f32_16x16x32_bf16 v[208:211], v[68:71], v[80:83], v[208:211]
    ds_read_b64_tr_b16 v[116:117], v15 offset:0
    buffer_store_dwordx4 v[164:167], v3, s[32:35], s61 offen offset:1024 sc1
    v_mfma_f32_16x16x32_bf16 v[212:215], v[68:71], v[84:87], v[212:215]
    ds_read_b64_tr_b16 v[118:119], v15 offset:1024
    v_cvt_pk_bf16_f32 v168, v168, v169
    v_mfma_f32_16x16x32_bf16 v[216:219], v[68:71], v[88:91], v[216:219]
    v_cvt_pk_bf16_f32 v169, v170, v171
    v_mfma_f32_16x16x32_bf16 v[220:223], v[68:71], v[92:95], v[220:223]
    s_waitcnt lgkmcnt(4)
    v_cvt_pk_bf16_f32 v170, v184, v185
    v_mfma_f32_16x16x32_bf16 v[192:195], v[72:75], v[96:99], v[192:195]
    v_cvt_pk_bf16_f32 v171, v186, v187
    v_mfma_f32_16x16x32_bf16 v[196:199], v[72:75], v[100:103], v[196:199]
    buffer_store_dwordx4 v[168:171], v3, s[32:35], s61 offen offset:2048 sc1
    v_mfma_f32_16x16x32_bf16 v[200:203], v[72:75], v[104:107], v[200:203]
    ds_read_b64_tr_b16 v[120:121], v14 offset:8192
    v_cvt_pk_bf16_f32 v172, v172, v173
    v_mfma_f32_16x16x32_bf16 v[204:207], v[72:75], v[108:111], v[204:207]
    ds_read_b64_tr_b16 v[122:123], v14 offset:9216
    v_cvt_pk_bf16_f32 v173, v174, v175
    v_mfma_f32_16x16x32_bf16 v[208:211], v[76:79], v[96:99], v[208:211]
    ds_read_b64_tr_b16 v[124:125], v15 offset:8192
    v_cvt_pk_bf16_f32 v174, v188, v189
    v_mfma_f32_16x16x32_bf16 v[212:215], v[76:79], v[100:103], v[212:215]
    ds_read_b64_tr_b16 v[126:127], v15 offset:9216
    v_cvt_pk_bf16_f32 v175, v190, v191
    v_mfma_f32_16x16x32_bf16 v[216:219], v[76:79], v[104:107], v[216:219]
    buffer_store_dwordx4 v[172:175], v3, s[32:35], s61 offen offset:3072 sc1
    v_mfma_f32_16x16x32_bf16 v[220:223], v[76:79], v[108:111], v[220:223]
    s_waitcnt lgkmcnt(4)
    s_xor_b32 s3, s60, 8
    v_mfma_f32_16x16x32_bf16 v[192:195], v[112:115], v[16:19], v[192:195]
    s_mul_i32 s3, s3, 49152
    v_mfma_f32_16x16x32_bf16 v[196:199], v[112:115], v[20:23], v[196:199]
    s_lshl_b32 s61, s46, 12
    v_mfma_f32_16x16x32_bf16 v[200:203], v[112:115], v[24:27], v[200:203]
    ds_read_b64_tr_b16 v[64:65], v12 offset:8192
    s_add_u32 s61, s61, s3
    v_mfma_f32_16x16x32_bf16 v[204:207], v[112:115], v[28:31], v[204:207]
    ds_read_b64_tr_b16 v[66:67], v12 offset:9216
    s_add_u32 s61, s61, 16793600
    v_mfma_f32_16x16x32_bf16 v[208:211], v[116:119], v[16:19], v[208:211]
    ds_read_b64_tr_b16 v[68:69], v13 offset:8192
    v_mfma_f32_16x16x32_bf16 v[212:215], v[116:119], v[20:23], v[212:215]
    ds_read_b64_tr_b16 v[70:71], v13 offset:9216
    v_mfma_f32_16x16x32_bf16 v[216:219], v[116:119], v[24:27], v[216:219]
    v_mfma_f32_16x16x32_bf16 v[220:223], v[116:119], v[28:31], v[220:223]
    s_waitcnt lgkmcnt(4)
    v_mfma_f32_16x16x32_bf16 v[192:195], v[120:123], v[48:51], v[192:195]
    v_add_u32 v14, -98304, v12
    v_mfma_f32_16x16x32_bf16 v[196:199], v[120:123], v[52:55], v[196:199]
    v_add_u32 v15, -98304, v13
    v_mfma_f32_16x16x32_bf16 v[200:203], v[120:123], v[56:59], v[200:203]
    ds_read_b64_tr_b16 v[72:73], v14 offset:49152
    v_mfma_f32_16x16x32_bf16 v[204:207], v[120:123], v[60:63], v[204:207]
    ds_read_b64_tr_b16 v[74:75], v14 offset:50176
    v_mfma_f32_16x16x32_bf16 v[208:211], v[124:127], v[48:51], v[208:211]
    ds_read_b64_tr_b16 v[76:77], v15 offset:49152
    v_mfma_f32_16x16x32_bf16 v[212:215], v[124:127], v[52:55], v[212:215]
    ds_read_b64_tr_b16 v[78:79], v15 offset:50176
    v_mfma_f32_16x16x32_bf16 v[216:219], v[124:127], v[56:59], v[216:219]
    v_mfma_f32_16x16x32_bf16 v[220:223], v[124:127], v[60:63], v[220:223]
    s_waitcnt lgkmcnt(4)
    v_mfma_f32_16x16x32_bf16 v[224:227], v[64:67], v[32:35], v[224:227]
    v_mfma_f32_16x16x32_bf16 v[228:231], v[64:67], v[36:39], v[228:231]
    v_mfma_f32_16x16x32_bf16 v[232:235], v[64:67], v[40:43], v[232:235]
    ds_read_b64_tr_b16 v[112:113], v14 offset:57344
    v_mfma_f32_16x16x32_bf16 v[236:239], v[64:67], v[44:47], v[236:239]
    ds_read_b64_tr_b16 v[114:115], v14 offset:58368
    v_cvt_pk_bf16_f32 v192, v192, v193
    v_mfma_f32_16x16x32_bf16 v[240:243], v[68:71], v[32:35], v[240:243]
    ds_read_b64_tr_b16 v[116:117], v15 offset:57344
    v_cvt_pk_bf16_f32 v193, v194, v195
    v_mfma_f32_16x16x32_bf16 v[244:247], v[68:71], v[36:39], v[244:247]
    ds_read_b64_tr_b16 v[118:119], v15 offset:58368
    v_cvt_pk_bf16_f32 v194, v208, v209
    v_mfma_f32_16x16x32_bf16 v[248:251], v[68:71], v[40:43], v[248:251]
    v_cvt_pk_bf16_f32 v195, v210, v211
    v_mfma_f32_16x16x32_bf16 v[252:255], v[68:71], v[44:47], v[252:255]
    s_waitcnt lgkmcnt(4)
    buffer_store_dwordx4 v[192:195], v3, s[32:35], s61 offen offset:0 sc1
    v_mfma_f32_16x16x32_bf16 v[224:227], v[72:75], v[80:83], v[224:227]
    v_cvt_pk_bf16_f32 v196, v196, v197
    v_mfma_f32_16x16x32_bf16 v[228:231], v[72:75], v[84:87], v[228:231]
    v_cvt_pk_bf16_f32 v197, v198, v199
    v_mfma_f32_16x16x32_bf16 v[232:235], v[72:75], v[88:91], v[232:235]
    ds_read_b64_tr_b16 v[120:121], v14 offset:0
    v_cvt_pk_bf16_f32 v198, v212, v213
    v_mfma_f32_16x16x32_bf16 v[236:239], v[72:75], v[92:95], v[236:239]
    ds_read_b64_tr_b16 v[122:123], v14 offset:1024
    v_cvt_pk_bf16_f32 v199, v214, v215
    v_mfma_f32_16x16x32_bf16 v[240:243], v[76:79], v[80:83], v[240:243]
    ds_read_b64_tr_b16 v[124:125], v15 offset:0
    buffer_store_dwordx4 v[196:199], v3, s[32:35], s61 offen offset:1024 sc1
    v_mfma_f32_16x16x32_bf16 v[244:247], v[76:79], v[84:87], v[244:247]
    ds_read_b64_tr_b16 v[126:127], v15 offset:1024
    v_cvt_pk_bf16_f32 v200, v200, v201
    v_mfma_f32_16x16x32_bf16 v[248:251], v[76:79], v[88:91], v[248:251]
    v_cvt_pk_bf16_f32 v201, v202, v203
    v_mfma_f32_16x16x32_bf16 v[252:255], v[76:79], v[92:95], v[252:255]
    s_waitcnt lgkmcnt(4)
    v_cvt_pk_bf16_f32 v202, v216, v217
    v_mfma_f32_16x16x32_bf16 v[224:227], v[112:115], v[96:99], v[224:227]
    v_cvt_pk_bf16_f32 v203, v218, v219
    v_mfma_f32_16x16x32_bf16 v[228:231], v[112:115], v[100:103], v[228:231]
    buffer_store_dwordx4 v[200:203], v3, s[32:35], s61 offen offset:2048 sc1
    v_mfma_f32_16x16x32_bf16 v[232:235], v[112:115], v[104:107], v[232:235]
    ds_read_b64_tr_b16 v[64:65], v14 offset:8192
    v_cvt_pk_bf16_f32 v204, v204, v205
    v_mfma_f32_16x16x32_bf16 v[236:239], v[112:115], v[108:111], v[236:239]
    ds_read_b64_tr_b16 v[66:67], v14 offset:9216
    v_cvt_pk_bf16_f32 v205, v206, v207
    v_mfma_f32_16x16x32_bf16 v[240:243], v[116:119], v[96:99], v[240:243]
    ds_read_b64_tr_b16 v[68:69], v15 offset:8192
    v_cvt_pk_bf16_f32 v206, v220, v221
    v_mfma_f32_16x16x32_bf16 v[244:247], v[116:119], v[100:103], v[244:247]
    ds_read_b64_tr_b16 v[70:71], v15 offset:9216
    v_cvt_pk_bf16_f32 v207, v222, v223
    v_mfma_f32_16x16x32_bf16 v[248:251], v[116:119], v[104:107], v[248:251]
    buffer_store_dwordx4 v[204:207], v3, s[32:35], s61 offen offset:3072 sc1
    v_mfma_f32_16x16x32_bf16 v[252:255], v[116:119], v[108:111], v[252:255]
    s_waitcnt lgkmcnt(4)
    s_xor_b32 s3, s60, 12
    v_mfma_f32_16x16x32_bf16 v[224:227], v[120:123], v[16:19], v[224:227]
    s_mul_i32 s3, s3, 49152
    v_mfma_f32_16x16x32_bf16 v[228:231], v[120:123], v[20:23], v[228:231]
    s_lshl_b32 s61, s46, 12
    v_mfma_f32_16x16x32_bf16 v[232:235], v[120:123], v[24:27], v[232:235]
    ds_read_b64_tr_b16 v[72:73], v6 offset:8192
    s_add_u32 s61, s61, s3
    v_mfma_f32_16x16x32_bf16 v[236:239], v[120:123], v[28:31], v[236:239]
    ds_read_b64_tr_b16 v[74:75], v6 offset:9216
    s_add_u32 s61, s61, 16809984
    v_mfma_f32_16x16x32_bf16 v[240:243], v[124:127], v[16:19], v[240:243]
    ds_read_b64_tr_b16 v[76:77], v7 offset:8192
    v_mfma_f32_16x16x32_bf16 v[244:247], v[124:127], v[20:23], v[244:247]
    ds_read_b64_tr_b16 v[78:79], v7 offset:9216
    v_mfma_f32_16x16x32_bf16 v[248:251], v[124:127], v[24:27], v[248:251]
    v_mfma_f32_16x16x32_bf16 v[252:255], v[124:127], v[28:31], v[252:255]
    s_waitcnt lgkmcnt(4)
    v_mfma_f32_16x16x32_bf16 v[224:227], v[64:67], v[48:51], v[224:227]
    v_add_u32 v14, -98304, v6
    v_mfma_f32_16x16x32_bf16 v[228:231], v[64:67], v[52:55], v[228:231]
    v_add_u32 v15, -98304, v7
    v_mfma_f32_16x16x32_bf16 v[232:235], v[64:67], v[56:59], v[232:235]
    ds_read_b64_tr_b16 v[112:113], v14 offset:49152
    v_mfma_f32_16x16x32_bf16 v[236:239], v[64:67], v[60:63], v[236:239]
    ds_read_b64_tr_b16 v[114:115], v14 offset:50176
    v_mfma_f32_16x16x32_bf16 v[240:243], v[68:71], v[48:51], v[240:243]
    ds_read_b64_tr_b16 v[116:117], v15 offset:49152
    v_mfma_f32_16x16x32_bf16 v[244:247], v[68:71], v[52:55], v[244:247]
    ds_read_b64_tr_b16 v[118:119], v15 offset:50176
    v_mfma_f32_16x16x32_bf16 v[248:251], v[68:71], v[56:59], v[248:251]
    v_mfma_f32_16x16x32_bf16 v[252:255], v[68:71], v[60:63], v[252:255]
    s_waitcnt lgkmcnt(4)
    v_mfma_f32_16x16x32_bf16 v[128:131], v[72:75], v[32:35], v[128:131]
    v_mfma_f32_16x16x32_bf16 v[132:135], v[72:75], v[36:39], v[132:135]
    v_mfma_f32_16x16x32_bf16 v[136:139], v[72:75], v[40:43], v[136:139]
    ds_read_b64_tr_b16 v[120:121], v14 offset:57344
    v_mfma_f32_16x16x32_bf16 v[140:143], v[72:75], v[44:47], v[140:143]
    ds_read_b64_tr_b16 v[122:123], v14 offset:58368
    v_cvt_pk_bf16_f32 v224, v224, v225
    v_cvt_pk_bf16_f32 v225, v226, v227
    v_cvt_pk_bf16_f32 v226, v240, v241
    v_cvt_pk_bf16_f32 v227, v242, v243
    buffer_store_dwordx4 v[224:227], v3, s[32:35], s61 offen offset:0 sc1
    v_mfma_f32_16x16x32_bf16 v[144:147], v[76:79], v[32:35], v[144:147]
    ds_read_b64_tr_b16 v[124:125], v15 offset:57344
    v_cvt_pk_bf16_f32 v228, v228, v229
    v_cvt_pk_bf16_f32 v229, v230, v231
    v_cvt_pk_bf16_f32 v230, v244, v245
    v_cvt_pk_bf16_f32 v231, v246, v247
    buffer_store_dwordx4 v[228:231], v3, s[32:35], s61 offen offset:1024 sc1
    v_mfma_f32_16x16x32_bf16 v[148:151], v[76:79], v[36:39], v[148:151]
    ds_read_b64_tr_b16 v[126:127], v15 offset:58368
    v_cvt_pk_bf16_f32 v232, v232, v233
    v_cvt_pk_bf16_f32 v233, v234, v235
    v_cvt_pk_bf16_f32 v234, v248, v249
    v_cvt_pk_bf16_f32 v235, v250, v251
    buffer_store_dwordx4 v[232:235], v3, s[32:35], s61 offen offset:2048 sc1
    v_mfma_f32_16x16x32_bf16 v[152:155], v[76:79], v[40:43], v[152:155]
    v_cvt_pk_bf16_f32 v236, v236, v237
    v_cvt_pk_bf16_f32 v237, v238, v239
    v_cvt_pk_bf16_f32 v238, v252, v253
    v_cvt_pk_bf16_f32 v239, v254, v255
    buffer_store_dwordx4 v[236:239], v3, s[32:35], s61 offen offset:3072 sc1
    v_mfma_f32_16x16x32_bf16 v[156:159], v[76:79], v[44:47], v[156:159]
    s_waitcnt lgkmcnt(4)
    s_xor_b32 s3, s60, 0
    s_mul_i32 s3, s3, 49152
    s_lshl_b32 s61, s46, 12
    s_add_u32 s61, s61, s3
    s_add_u32 s61, s61, 16777216
    v_mfma_f32_16x16x32_bf16 v[128:131], v[112:115], v[80:83], v[128:131]
    v_mfma_f32_16x16x32_bf16 v[132:135], v[112:115], v[84:87], v[132:135]
    v_mfma_f32_16x16x32_bf16 v[136:139], v[112:115], v[88:91], v[136:139]
    ds_read_b64_tr_b16 v[64:65], v14 offset:0
    v_mfma_f32_16x16x32_bf16 v[140:143], v[112:115], v[92:95], v[140:143]
    ds_read_b64_tr_b16 v[66:67], v14 offset:1024
    v_mfma_f32_16x16x32_bf16 v[144:147], v[116:119], v[80:83], v[144:147]
    ds_read_b64_tr_b16 v[68:69], v15 offset:0
    v_mfma_f32_16x16x32_bf16 v[148:151], v[116:119], v[84:87], v[148:151]
    ds_read_b64_tr_b16 v[70:71], v15 offset:1024
    v_mfma_f32_16x16x32_bf16 v[152:155], v[116:119], v[88:91], v[152:155]
    v_mfma_f32_16x16x32_bf16 v[156:159], v[116:119], v[92:95], v[156:159]
    s_waitcnt lgkmcnt(4)
    v_mfma_f32_16x16x32_bf16 v[128:131], v[120:123], v[96:99], v[128:131]
    v_mfma_f32_16x16x32_bf16 v[132:135], v[120:123], v[100:103], v[132:135]
    v_mfma_f32_16x16x32_bf16 v[136:139], v[120:123], v[104:107], v[136:139]
    ds_read_b64_tr_b16 v[72:73], v14 offset:8192
    v_mfma_f32_16x16x32_bf16 v[140:143], v[120:123], v[108:111], v[140:143]
    ds_read_b64_tr_b16 v[74:75], v14 offset:9216
    v_mfma_f32_16x16x32_bf16 v[144:147], v[124:127], v[96:99], v[144:147]
    ds_read_b64_tr_b16 v[76:77], v15 offset:8192
    v_mfma_f32_16x16x32_bf16 v[148:151], v[124:127], v[100:103], v[148:151]
    ds_read_b64_tr_b16 v[78:79], v15 offset:9216
    v_mfma_f32_16x16x32_bf16 v[152:155], v[124:127], v[104:107], v[152:155]
    v_mfma_f32_16x16x32_bf16 v[156:159], v[124:127], v[108:111], v[156:159]
    s_waitcnt lgkmcnt(4)
    v_mfma_f32_16x16x32_bf16 v[128:131], v[64:67], v[16:19], v[128:131]
    v_mfma_f32_16x16x32_bf16 v[132:135], v[64:67], v[20:23], v[132:135]
    v_mfma_f32_16x16x32_bf16 v[136:139], v[64:67], v[24:27], v[136:139]
    v_mfma_f32_16x16x32_bf16 v[140:143], v[64:67], v[28:31], v[140:143]
    v_mfma_f32_16x16x32_bf16 v[144:147], v[68:71], v[16:19], v[144:147]
    v_mfma_f32_16x16x32_bf16 v[148:151], v[68:71], v[20:23], v[148:151]
    v_mfma_f32_16x16x32_bf16 v[152:155], v[68:71], v[24:27], v[152:155]
    v_mfma_f32_16x16x32_bf16 v[156:159], v[68:71], v[28:31], v[156:159]
    s_waitcnt lgkmcnt(0)
    v_mfma_f32_16x16x32_bf16 v[128:131], v[72:75], v[48:51], v[128:131]
    v_mfma_f32_16x16x32_bf16 v[132:135], v[72:75], v[52:55], v[132:135]
    v_mfma_f32_16x16x32_bf16 v[136:139], v[72:75], v[56:59], v[136:139]
    v_mfma_f32_16x16x32_bf16 v[140:143], v[72:75], v[60:63], v[140:143]
    v_mfma_f32_16x16x32_bf16 v[144:147], v[76:79], v[48:51], v[144:147]
    v_mfma_f32_16x16x32_bf16 v[148:151], v[76:79], v[52:55], v[148:151]
    v_mfma_f32_16x16x32_bf16 v[152:155], v[76:79], v[56:59], v[152:155]
    v_mfma_f32_16x16x32_bf16 v[156:159], v[76:79], v[60:63], v[156:159]
    v_and_b32 v4, 15, v0
    v_lshlrev_b32 v4, 12, v4
    v_lshrrev_b32 v5, 8, v2
    v_lshl_add_u32 v4, v5, 4, v4
    s_lshl_b32 s63, s44, 19
    s_lshl_b32 s3, s49, 18
    s_add_u32 s63, s63, s3
    s_lshl_b32 s3, s42, 11
    s_add_u32 s63, s63, s3
    s_lshl_b32 s3, s71, 9
    s_add_u32 s63, s63, s3
    s_lshl_b32 s3, s43, 7
    s_add_u32 s63, s63, s3
    s_lshl_b32 s3, s50, 6
    s_add_u32 s63, s63, s3
    v_lshlrev_b32 v5, 2, v0
    v_xor_b32 v6, s60, v5
    v_lshl_add_u32 v6, v6, 10, v5
    s_lshl_b32 s62, s46, 7
    s_add_u32 s62, s62, 31457536
    s_lshl_b32 s3, s60, 10
    s_add_u32 s64, s62, s3
    v_mov_b32 v7, 1
    s_mov_b32 s72, 0
    s_and_b32 s3, s43, 1
    s_cmp_eq_u32 s3, 0
    s_cselect_b32 s8, 2, 1
    s_cselect_b32 s9, 1, 3
    s_cselect_b32 s10, 3, 2
    s_lshl_b32 s3, s8, 14
    s_add_u32 s3, s3, s61
    s_sub_u32 s12, s3, 16384
    s_lshl_b32 s8, 1, s8
    s_lshl_b32 s3, s9, 14
    s_add_u32 s3, s3, s61
    s_sub_u32 s13, s3, 16384
    s_lshl_b32 s9, 1, s9
    s_lshl_b32 s3, s10, 14
    s_add_u32 s3, s3, s61
    s_sub_u32 s14, s3, 16384
    s_lshl_b32 s10, 1, s10
    s_mov_b32 s16, 0
    s_mov_b32 s17, 0
    s_mov_b32 s65, 0xffff0000
    s_mov_b64 exec, 14
    s_waitcnt vmcnt(0)
    buffer_load_dword v8, v5, s[32:35], s64 offen sc1
    buffer_store_dword v7, v6, s[32:35], s62 offen sc1
    s_waitcnt vmcnt(1)
    s_branch L_x2got
L_x2poll:
    s_mov_b64 exec, 14
    buffer_load_dword v8, v5, s[32:35], s64 offen sc1
    s_mov_b64 exec, -1
    s_waitcnt vmcnt(1)
    s_cmp_lg_u32 s17, 0
    s_cbranch_scc1 L_na_12
    s_and_b32 s3, s16, s8
    s_cbranch_scc0 L_na_12
    v_lshlrev_b32 v64, 16, v16
    v_and_b32 v65, s65, v16
    v_pk_add_f32 v[128:129], v[128:129], v[64:65]
    v_lshlrev_b32 v66, 16, v17
    v_and_b32 v67, s65, v17
    v_pk_add_f32 v[130:131], v[130:131], v[66:67]
    v_lshlrev_b32 v68, 16, v18
    v_and_b32 v69, s65, v18
    v_pk_add_f32 v[144:145], v[144:145], v[68:69]
    v_lshlrev_b32 v70, 16, v19
    v_and_b32 v71, s65, v19
    v_pk_add_f32 v[146:147], v[146:147], v[70:71]
    v_lshlrev_b32 v64, 16, v20
    v_and_b32 v65, s65, v20
    v_pk_add_f32 v[132:133], v[132:133], v[64:65]
    v_lshlrev_b32 v66, 16, v21
    v_and_b32 v67, s65, v21
    v_pk_add_f32 v[134:135], v[134:135], v[66:67]
    v_lshlrev_b32 v68, 16, v22
    v_and_b32 v69, s65, v22
    v_pk_add_f32 v[148:149], v[148:149], v[68:69]
    v_lshlrev_b32 v70, 16, v23
    v_and_b32 v71, s65, v23
    v_pk_add_f32 v[150:151], v[150:151], v[70:71]
    v_lshlrev_b32 v64, 16, v24
    v_and_b32 v65, s65, v24
    v_pk_add_f32 v[136:137], v[136:137], v[64:65]
    v_lshlrev_b32 v66, 16, v25
    v_and_b32 v67, s65, v25
    v_pk_add_f32 v[138:139], v[138:139], v[66:67]
    v_lshlrev_b32 v68, 16, v26
    v_and_b32 v69, s65, v26
    v_pk_add_f32 v[152:153], v[152:153], v[68:69]
    v_lshlrev_b32 v70, 16, v27
    v_and_b32 v71, s65, v27
    v_pk_add_f32 v[154:155], v[154:155], v[70:71]
    v_lshlrev_b32 v64, 16, v28
    v_and_b32 v65, s65, v28
    v_pk_add_f32 v[140:141], v[140:141], v[64:65]
    v_lshlrev_b32 v66, 16, v29
    v_and_b32 v67, s65, v29
    v_pk_add_f32 v[142:143], v[142:143], v[66:67]
    v_lshlrev_b32 v68, 16, v30
    v_and_b32 v69, s65, v30
    v_pk_add_f32 v[156:157], v[156:157], v[68:69]
    v_lshlrev_b32 v70, 16, v31
    v_and_b32 v71, s65, v31
    v_pk_add_f32 v[158:159], v[158:159], v[70:71]
    s_mov_b32 s17, 1
L_na_12:
    s_cmp_lg_u32 s17, 1
    s_cbranch_scc1 L_na_13
    s_and_b32 s3, s16, s9
    s_cbranch_scc0 L_na_13
    v_lshlrev_b32 v64, 16, v32
    v_and_b32 v65, s65, v32
    v_pk_add_f32 v[128:129], v[128:129], v[64:65]
    v_lshlrev_b32 v66, 16, v33
    v_and_b32 v67, s65, v33
    v_pk_add_f32 v[130:131], v[130:131], v[66:67]
    v_lshlrev_b32 v68, 16, v34
    v_and_b32 v69, s65, v34
    v_pk_add_f32 v[144:145], v[144:145], v[68:69]
    v_lshlrev_b32 v70, 16, v35
    v_and_b32 v71, s65, v35
    v_pk_add_f32 v[146:147], v[146:147], v[70:71]
    v_lshlrev_b32 v64, 16, v36
    v_and_b32 v65, s65, v36
    v_pk_add_f32 v[132:133], v[132:133], v[64:65]
    v_lshlrev_b32 v66, 16, v37
    v_and_b32 v67, s65, v37
    v_pk_add_f32 v[134:135], v[134:135], v[66:67]
    v_lshlrev_b32 v68, 16, v38
    v_and_b32 v69, s65, v38
    v_pk_add_f32 v[148:149], v[148:149], v[68:69]
    v_lshlrev_b32 v70, 16, v39
    v_and_b32 v71, s65, v39
    v_pk_add_f32 v[150:151], v[150:151], v[70:71]
    v_lshlrev_b32 v64, 16, v40
    v_and_b32 v65, s65, v40
    v_pk_add_f32 v[136:137], v[136:137], v[64:65]
    v_lshlrev_b32 v66, 16, v41
    v_and_b32 v67, s65, v41
    v_pk_add_f32 v[138:139], v[138:139], v[66:67]
    v_lshlrev_b32 v68, 16, v42
    v_and_b32 v69, s65, v42
    v_pk_add_f32 v[152:153], v[152:153], v[68:69]
    v_lshlrev_b32 v70, 16, v43
    v_and_b32 v71, s65, v43
    v_pk_add_f32 v[154:155], v[154:155], v[70:71]
    v_lshlrev_b32 v64, 16, v44
    v_and_b32 v65, s65, v44
    v_pk_add_f32 v[140:141], v[140:141], v[64:65]
    v_lshlrev_b32 v66, 16, v45
    v_and_b32 v67, s65, v45
    v_pk_add_f32 v[142:143], v[142:143], v[66:67]
    v_lshlrev_b32 v68, 16, v46
    v_and_b32 v69, s65, v46
    v_pk_add_f32 v[156:157], v[156:157], v[68:69]
    v_lshlrev_b32 v70, 16, v47
    v_and_b32 v71, s65, v47
    v_pk_add_f32 v[158:159], v[158:159], v[70:71]
    s_mov_b32 s17, 2
L_na_13:
    s_mov_b64 exec, 14
    s_waitcnt vmcnt(0)
L_x2got:
    v_cmp_eq_u32 vcc, 1, v8
    s_add_u32 s72, s72, 1
    s_mov_b64 exec, -1
    s_cmp_lt_u32 s72, 0x80000
    s_cselect_b32 s62, vcc_lo, 14
    s_andn2_b32 s62, s62, s16
    s_and_b32 s3, s62, s8
    s_cbranch_scc0 L_nl_14
    buffer_load_dwordx4 v[16:19], v3, s[32:35], s12 offen offset:0 sc1
    buffer_load_dwordx4 v[20:23], v3, s[32:35], s12 offen offset:1024 sc1
    buffer_load_dwordx4 v[24:27], v3, s[32:35], s12 offen offset:2048 sc1
    buffer_load_dwordx4 v[28:31], v3, s[32:35], s12 offen offset:3072 sc1
L_nl_14:
    s_and_b32 s3, s62, s9
    s_cbranch_scc0 L_nl_15
    buffer_load_dwordx4 v[32:35], v3, s[32:35], s13 offen offset:0 sc1
    buffer_load_dwordx4 v[36:39], v3, s[32:35], s13 offen offset:1024 sc1
    buffer_load_dwordx4 v[40:43], v3, s[32:35], s13 offen offset:2048 sc1
    buffer_load_dwordx4 v[44:47], v3, s[32:35], s13 offen offset:3072 sc1
L_nl_15:
    s_and_b32 s3, s62, s10
    s_cbranch_scc0 L_nl_16
    buffer_load_dwordx4 v[48:51], v3, s[32:35], s14 offen offset:0 sc1
    buffer_load_dwordx4 v[52:55], v3, s[32:35], s14 offen offset:1024 sc1
    buffer_load_dwordx4 v[56:59], v3, s[32:35], s14 offen offset:2048 sc1
    buffer_load_dwordx4 v[60:63], v3, s[32:35], s14 offen offset:3072 sc1
L_nl_16:
    s_or_b32 s16, s16, s62
    s_cmp_lg_u32 s16, 14
    s_cbranch_scc1 L_x2poll
    s_waitcnt vmcnt(0)
    s_cmp_eq_u32 s17, 2
    s_cbranch_scc1 L_x2a2
    s_cmp_eq_u32 s17, 1
    s_cbranch_scc1 L_x2a1
    v_lshlrev_b32 v64, 16, v16
    v_and_b32 v65, s65, v16
    v_pk_add_f32 v[128:129], v[128:129], v[64:65]
    v_lshlrev_b32 v66, 16, v17
    v_and_b32 v67, s65, v17
    v_pk_add_f32 v[130:131], v[130:131], v[66:67]
    v_lshlrev_b32 v68, 16, v18
    v_and_b32 v69, s65, v18
    v_pk_add_f32 v[144:145], v[144:145], v[68:69]
    v_lshlrev_b32 v70, 16, v19
    v_and_b32 v71, s65, v19
    v_pk_add_f32 v[146:147], v[146:147], v[70:71]
    v_lshlrev_b32 v64, 16, v20
    v_and_b32 v65, s65, v20
    v_pk_add_f32 v[132:133], v[132:133], v[64:65]
    v_lshlrev_b32 v66, 16, v21
    v_and_b32 v67, s65, v21
    v_pk_add_f32 v[134:135], v[134:135], v[66:67]
    v_lshlrev_b32 v68, 16, v22
    v_and_b32 v69, s65, v22
    v_pk_add_f32 v[148:149], v[148:149], v[68:69]
    v_lshlrev_b32 v70, 16, v23
    v_and_b32 v71, s65, v23
    v_pk_add_f32 v[150:151], v[150:151], v[70:71]
    v_lshlrev_b32 v64, 16, v24
    v_and_b32 v65, s65, v24
    v_pk_add_f32 v[136:137], v[136:137], v[64:65]
    v_lshlrev_b32 v66, 16, v25
    v_and_b32 v67, s65, v25
    v_pk_add_f32 v[138:139], v[138:139], v[66:67]
    v_lshlrev_b32 v68, 16, v26
    v_and_b32 v69, s65, v26
    v_pk_add_f32 v[152:153], v[152:153], v[68:69]
    v_lshlrev_b32 v70, 16, v27
    v_and_b32 v71, s65, v27
    v_pk_add_f32 v[154:155], v[154:155], v[70:71]
    v_lshlrev_b32 v64, 16, v28
    v_and_b32 v65, s65, v28
    v_pk_add_f32 v[140:141], v[140:141], v[64:65]
    v_lshlrev_b32 v66, 16, v29
    v_and_b32 v67, s65, v29
    v_pk_add_f32 v[142:143], v[142:143], v[66:67]
    v_lshlrev_b32 v68, 16, v30
    v_and_b32 v69, s65, v30
    v_pk_add_f32 v[156:157], v[156:157], v[68:69]
    v_lshlrev_b32 v70, 16, v31
    v_and_b32 v71, s65, v31
    v_pk_add_f32 v[158:159], v[158:159], v[70:71]
L_x2a1:
    v_lshlrev_b32 v64, 16, v32
    v_and_b32 v65, s65, v32
    v_pk_add_f32 v[128:129], v[128:129], v[64:65]
    v_lshlrev_b32 v66, 16, v33
    v_and_b32 v67, s65, v33
    v_pk_add_f32 v[130:131], v[130:131], v[66:67]
    v_lshlrev_b32 v68, 16, v34
    v_and_b32 v69, s65, v34
    v_pk_add_f32 v[144:145], v[144:145], v[68:69]
    v_lshlrev_b32 v70, 16, v35
    v_and_b32 v71, s65, v35
    v_pk_add_f32 v[146:147], v[146:147], v[70:71]
    v_lshlrev_b32 v64, 16, v36
    v_and_b32 v65, s65, v36
    v_pk_add_f32 v[132:133], v[132:133], v[64:65]
    v_lshlrev_b32 v66, 16, v37
    v_and_b32 v67, s65, v37
    v_pk_add_f32 v[134:135], v[134:135], v[66:67]
    v_lshlrev_b32 v68, 16, v38
    v_and_b32 v69, s65, v38
    v_pk_add_f32 v[148:149], v[148:149], v[68:69]
    v_lshlrev_b32 v70, 16, v39
    v_and_b32 v71, s65, v39
    v_pk_add_f32 v[150:151], v[150:151], v[70:71]
    v_lshlrev_b32 v64, 16, v40
    v_and_b32 v65, s65, v40
    v_pk_add_f32 v[136:137], v[136:137], v[64:65]
    v_lshlrev_b32 v66, 16, v41
    v_and_b32 v67, s65, v41
    v_pk_add_f32 v[138:139], v[138:139], v[66:67]
    v_lshlrev_b32 v68, 16, v42
    v_and_b32 v69, s65, v42
    v_pk_add_f32 v[152:153], v[152:153], v[68:69]
    v_lshlrev_b32 v70, 16, v43
    v_and_b32 v71, s65, v43
    v_pk_add_f32 v[154:155], v[154:155], v[70:71]
    v_lshlrev_b32 v64, 16, v44
    v_and_b32 v65, s65, v44
    v_pk_add_f32 v[140:141], v[140:141], v[64:65]
    v_lshlrev_b32 v66, 16, v45
    v_and_b32 v67, s65, v45
    v_pk_add_f32 v[142:143], v[142:143], v[66:67]
    v_lshlrev_b32 v68, 16, v46
    v_and_b32 v69, s65, v46
    v_pk_add_f32 v[156:157], v[156:157], v[68:69]
    v_lshlrev_b32 v70, 16, v47
    v_and_b32 v71, s65, v47
    v_pk_add_f32 v[158:159], v[158:159], v[70:71]
L_x2a2:
    v_lshlrev_b32 v64, 16, v48
    v_and_b32 v65, s65, v48
    v_pk_add_f32 v[128:129], v[128:129], v[64:65]
    v_lshlrev_b32 v66, 16, v49
    v_and_b32 v67, s65, v49
    v_pk_add_f32 v[130:131], v[130:131], v[66:67]
    v_lshlrev_b32 v68, 16, v50
    v_and_b32 v69, s65, v50
    v_pk_add_f32 v[144:145], v[144:145], v[68:69]
    v_lshlrev_b32 v70, 16, v51
    v_and_b32 v71, s65, v51
    v_pk_add_f32 v[146:147], v[146:147], v[70:71]
    v_lshlrev_b32 v64, 16, v52
    v_and_b32 v65, s65, v52
    v_pk_add_f32 v[132:133], v[132:133], v[64:65]
    v_lshlrev_b32 v66, 16, v53
    v_and_b32 v67, s65, v53
    v_pk_add_f32 v[134:135], v[134:135], v[66:67]
    v_lshlrev_b32 v68, 16, v54
    v_and_b32 v69, s65, v54
    v_pk_add_f32 v[148:149], v[148:149], v[68:69]
    v_lshlrev_b32 v70, 16, v55
    v_and_b32 v71, s65, v55
    v_pk_add_f32 v[150:151], v[150:151], v[70:71]
    v_lshlrev_b32 v64, 16, v56
    v_and_b32 v65, s65, v56
    v_pk_add_f32 v[136:137], v[136:137], v[64:65]
    v_lshlrev_b32 v66, 16, v57
    v_and_b32 v67, s65, v57
    v_pk_add_f32 v[138:139], v[138:139], v[66:67]
    v_lshlrev_b32 v68, 16, v58
    v_and_b32 v69, s65, v58
    v_pk_add_f32 v[152:153], v[152:153], v[68:69]
    v_lshlrev_b32 v70, 16, v59
    v_and_b32 v71, s65, v59
    v_pk_add_f32 v[154:155], v[154:155], v[70:71]
    v_lshlrev_b32 v64, 16, v60
    v_and_b32 v65, s65, v60
    v_pk_add_f32 v[140:141], v[140:141], v[64:65]
    v_lshlrev_b32 v66, 16, v61
    v_and_b32 v67, s65, v61
    v_pk_add_f32 v[142:143], v[142:143], v[66:67]
    v_lshlrev_b32 v68, 16, v62
    v_and_b32 v69, s65, v62
    v_pk_add_f32 v[156:157], v[156:157], v[68:69]
    v_lshlrev_b32 v70, 16, v63
    v_and_b32 v71, s65, v63
    v_pk_add_f32 v[158:159], v[158:159], v[70:71]
    v_cvt_pk_bf16_f32 v16, v128, v129
    v_cvt_pk_bf16_f32 v17, v130, v131
    v_cvt_pk_bf16_f32 v18, v144, v145
    v_cvt_pk_bf16_f32 v19, v146, v147
    v_cvt_pk_bf16_f32 v20, v132, v133
    v_cvt_pk_bf16_f32 v21, v134, v135
    v_cvt_pk_bf16_f32 v22, v148, v149
    v_cvt_pk_bf16_f32 v23, v150, v151
    v_permlane16_swap_b32 v16, v18
    v_permlane16_swap_b32 v17, v19
    v_permlane16_swap_b32 v20, v22
    v_permlane16_swap_b32 v21, v23
    buffer_store_dwordx4 v[16:19], v4, s[28:31], s63 offen
    s_add_u32 s63, s63, 65536
    buffer_store_dwordx4 v[20:23], v4, s[28:31], s63 offen
    s_add_u32 s63, s63, 65536
    v_cvt_pk_bf16_f32 v24, v136, v137
    v_cvt_pk_bf16_f32 v25, v138, v139
    v_cvt_pk_bf16_f32 v26, v152, v153
    v_cvt_pk_bf16_f32 v27, v154, v155
    v_cvt_pk_bf16_f32 v28, v140, v141
    v_cvt_pk_bf16_f32 v29, v142, v143
    v_cvt_pk_bf16_f32 v30, v156, v157
    v_cvt_pk_bf16_f32 v31, v158, v159
    v_permlane16_swap_b32 v24, v26
    v_permlane16_swap_b32 v25, v27
    v_permlane16_swap_b32 v28, v30
    v_permlane16_swap_b32 v29, v31
    buffer_store_dwordx4 v[24:27], v4, s[28:31], s63 offen
    s_add_u32 s63, s63, 65536
    buffer_store_dwordx4 v[28:31], v4, s[28:31], s63 offen
    s_add_u32 s63, s63, 65536
L_fin:
    s_endpgm
L_slow_8:
    s_nop 7
    v_max3_f32 v247, v96, v97, v98
    v_max3_f32 v247, v247, v99, v104
    v_max3_f32 v247, v247, v105, v106
    v_max_f32 v247, v247, v107
    v_max3_f32 v248, v100, v101, v102
    v_max3_f32 v248, v248, v103, v108
    v_max3_f32 v248, v248, v109, v110
    v_max_f32 v248, v248, v111
    v_mov_b32 v249, v247
    v_mov_b32 v250, v248
    s_nop 0
    v_permlane16_swap_b32 v247, v249
    v_permlane16_swap_b32 v248, v250
    s_nop 0
    v_max_f32 v247, v247, v249
    v_max_f32 v248, v248, v250
    v_mov_b32 v249, v247
    v_mov_b32 v250, v248
    s_nop 0
    v_permlane32_swap_b32 v247, v249
    v_permlane32_swap_b32 v248, v250
    s_nop 0
    v_max_f32 v247, v247, v249
    v_max_f32 v248, v248, v250
    v_add_f32 v247, 0x40e00000, v247
    v_add_f32 v248, 0x40e00000, v248
    v_max_f32 v247, 0, v247
    v_max_f32 v248, 0, v248
    v_sub_f32 v249, 0, v247
    v_sub_f32 v250, 0, v248
    v_exp_f32 v249, v249
    v_exp_f32 v250, v250
    v_sub_f32 v80, v80, v247
    v_sub_f32 v81, v81, v247
    v_sub_f32 v82, v82, v247
    v_sub_f32 v83, v83, v247
    v_sub_f32 v88, v88, v247
    v_sub_f32 v89, v89, v247
    v_sub_f32 v90, v90, v247
    v_sub_f32 v91, v91, v247
    v_sub_f32 v96, v96, v247
    v_sub_f32 v97, v97, v247
    v_sub_f32 v98, v98, v247
    v_sub_f32 v99, v99, v247
    v_sub_f32 v104, v104, v247
    v_sub_f32 v105, v105, v247
    v_sub_f32 v106, v106, v247
    v_sub_f32 v107, v107, v247
    v_sub_f32 v192, v192, v247
    v_sub_f32 v193, v193, v247
    v_sub_f32 v194, v194, v247
    v_sub_f32 v195, v195, v247
    v_mul_f32 v200, v200, v249
    v_mul_f32 v201, v201, v249
    v_mul_f32 v202, v202, v249
    v_mul_f32 v203, v203, v249
    v_sub_f32 v84, v84, v248
    v_sub_f32 v85, v85, v248
    v_sub_f32 v86, v86, v248
    v_sub_f32 v87, v87, v248
    v_sub_f32 v92, v92, v248
    v_sub_f32 v93, v93, v248
    v_sub_f32 v94, v94, v248
    v_sub_f32 v95, v95, v248
    v_sub_f32 v100, v100, v248
    v_sub_f32 v101, v101, v248
    v_sub_f32 v102, v102, v248
    v_sub_f32 v103, v103, v248
    v_sub_f32 v108, v108, v248
    v_sub_f32 v109, v109, v248
    v_sub_f32 v110, v110, v248
    v_sub_f32 v111, v111, v248
    v_sub_f32 v196, v196, v248
    v_sub_f32 v197, v197, v248
    v_sub_f32 v198, v198, v248
    v_sub_f32 v199, v199, v248
    v_mul_f32 v204, v204, v250
    v_mul_f32 v205, v205, v250
    v_mul_f32 v206, v206, v250
    v_mul_f32 v207, v207, v250
    v_mul_f32 v128, v128, v249
    v_mul_f32 v129, v129, v249
    v_mul_f32 v130, v130, v249
    v_mul_f32 v131, v131, v249
    v_mul_f32 v132, v132, v250
    v_mul_f32 v133, v133, v250
    v_mul_f32 v134, v134, v250
    v_mul_f32 v135, v135, v250
    v_mul_f32 v136, v136, v249
    v_mul_f32 v137, v137, v249
    v_mul_f32 v138, v138, v249
    v_mul_f32 v139, v139, v249
    v_mul_f32 v140, v140, v250
    v_mul_f32 v141, v141, v250
    v_mul_f32 v142, v142, v250
    v_mul_f32 v143, v143, v250
    v_mul_f32 v144, v144, v249
    v_mul_f32 v145, v145, v249
    v_mul_f32 v146, v146, v249
    v_mul_f32 v147, v147, v249
    v_mul_f32 v148, v148, v250
    v_mul_f32 v149, v149, v250
    v_mul_f32 v150, v150, v250
    v_mul_f32 v151, v151, v250
    v_mul_f32 v152, v152, v249
    v_mul_f32 v153, v153, v249
    v_mul_f32 v154, v154, v249
    v_mul_f32 v155, v155, v249
    v_mul_f32 v156, v156, v250
    v_mul_f32 v157, v157, v250
    v_mul_f32 v158, v158, v250
    v_mul_f32 v159, v159, v250
    v_mul_f32 v160, v160, v249
    v_mul_f32 v161, v161, v249
    v_mul_f32 v162, v162, v249
    v_mul_f32 v163, v163, v249
    v_mul_f32 v164, v164, v250
    v_mul_f32 v165, v165, v250
    v_mul_f32 v166, v166, v250
    v_mul_f32 v167, v167, v250
    v_mul_f32 v168, v168, v249
    v_mul_f32 v169, v169, v249
    v_mul_f32 v170, v170, v249
    v_mul_f32 v171, v171, v249
    v_mul_f32 v172, v172, v250
    v_mul_f32 v173, v173, v250
    v_mul_f32 v174, v174, v250
    v_mul_f32 v175, v175, v250
    v_mul_f32 v176, v176, v249
    v_mul_f32 v177, v177, v249
    v_mul_f32 v178, v178, v249
    v_mul_f32 v179, v179, v249
    v_mul_f32 v180, v180, v250
    v_mul_f32 v181, v181, v250
    v_mul_f32 v182, v182, v250
    v_mul_f32 v183, v183, v250
    v_mul_f32 v184, v184, v249
    v_mul_f32 v185, v185, v249
    v_mul_f32 v186, v186, v249
    v_mul_f32 v187, v187, v249
    v_mul_f32 v188, v188, v250
    v_mul_f32 v189, v189, v250
    v_mul_f32 v190, v190, v250
    v_mul_f32 v191, v191, v250
    v_exp_f32 v212, v96
    v_exp_f32 v213, v97
    v_exp_f32 v214, v98
    v_cvt_pk_bf16_f32 v120, v212, v213
    v_exp_f32 v215, v99
    v_exp_f32 v216, v104
    v_cvt_pk_bf16_f32 v121, v214, v215
    v_exp_f32 v217, v105
    v_exp_f32 v218, v106
    v_cvt_pk_bf16_f32 v122, v216, v217
    v_exp_f32 v219, v107
    v_exp_f32 v212, v100
    v_cvt_pk_bf16_f32 v123, v218, v219
    v_exp_f32 v213, v101
    v_exp_f32 v214, v102
    v_cvt_pk_bf16_f32 v124, v212, v213
    v_exp_f32 v215, v103
    v_exp_f32 v216, v108
    v_cvt_pk_bf16_f32 v125, v214, v215
    v_exp_f32 v217, v109
    v_exp_f32 v218, v110
    v_cvt_pk_bf16_f32 v126, v216, v217
    v_exp_f32 v219, v111
    s_nop 0
    v_cvt_pk_bf16_f32 v127, v218, v219
    s_nop 1
    s_branch L_slow_8_ret
L_slow_9:
    s_nop 7
    v_max3_f32 v247, v80, v81, v82
    v_max3_f32 v247, v247, v83, v88
    v_max3_f32 v247, v247, v89, v90
    v_max_f32 v247, v247, v91
    v_max3_f32 v248, v84, v85, v86
    v_max3_f32 v248, v248, v87, v92
    v_max3_f32 v248, v248, v93, v94
    v_max_f32 v248, v248, v95
    v_mov_b32 v249, v247
    v_mov_b32 v250, v248
    s_nop 0
    v_permlane16_swap_b32 v247, v249
    v_permlane16_swap_b32 v248, v250
    s_nop 0
    v_max_f32 v247, v247, v249
    v_max_f32 v248, v248, v250
    v_mov_b32 v249, v247
    v_mov_b32 v250, v248
    s_nop 0
    v_permlane32_swap_b32 v247, v249
    v_permlane32_swap_b32 v248, v250
    s_nop 0
    v_max_f32 v247, v247, v249
    v_max_f32 v248, v248, v250
    v_add_f32 v247, 0x40e00000, v247
    v_add_f32 v248, 0x40e00000, v248
    v_max_f32 v247, 0, v247
    v_max_f32 v248, 0, v248
    v_sub_f32 v249, 0, v247
    v_sub_f32 v250, 0, v248
    v_exp_f32 v249, v249
    v_exp_f32 v250, v250
    v_sub_f32 v80, v80, v247
    v_sub_f32 v81, v81, v247
    v_sub_f32 v82, v82, v247
    v_sub_f32 v83, v83, v247
    v_sub_f32 v88, v88, v247
    v_sub_f32 v89, v89, v247
    v_sub_f32 v90, v90, v247
    v_sub_f32 v91, v91, v247
    v_sub_f32 v96, v96, v247
    v_sub_f32 v97, v97, v247
    v_sub_f32 v98, v98, v247
    v_sub_f32 v99, v99, v247
    v_sub_f32 v104, v104, v247
    v_sub_f32 v105, v105, v247
    v_sub_f32 v106, v106, v247
    v_sub_f32 v107, v107, v247
    v_sub_f32 v192, v192, v247
    v_sub_f32 v193, v193, v247
    v_sub_f32 v194, v194, v247
    v_sub_f32 v195, v195, v247
    v_mul_f32 v200, v200, v249
    v_mul_f32 v201, v201, v249
    v_mul_f32 v202, v202, v249
    v_mul_f32 v203, v203, v249
    v_sub_f32 v84, v84, v248
    v_sub_f32 v85, v85, v248
    v_sub_f32 v86, v86, v248
    v_sub_f32 v87, v87, v248
    v_sub_f32 v92, v92, v248
    v_sub_f32 v93, v93, v248
    v_sub_f32 v94, v94, v248
    v_sub_f32 v95, v95, v248
    v_sub_f32 v100, v100, v248
    v_sub_f32 v101, v101, v248
    v_sub_f32 v102, v102, v248
    v_sub_f32 v103, v103, v248
    v_sub_f32 v108, v108, v248
    v_sub_f32 v109, v109, v248
    v_sub_f32 v110, v110, v248
    v_sub_f32 v111, v111, v248
    v_sub_f32 v196, v196, v248
    v_sub_f32 v197, v197, v248
    v_sub_f32 v198, v198, v248
    v_sub_f32 v199, v199, v248
    v_mul_f32 v204, v204, v250
    v_mul_f32 v205, v205, v250
    v_mul_f32 v206, v206, v250
    v_mul_f32 v207, v207, v250
    v_mul_f32 v128, v128, v249
    v_mul_f32 v129, v129, v249
    v_mul_f32 v130, v130, v249
    v_mul_f32 v131, v131, v249
    v_mul_f32 v132, v132, v250
    v_mul_f32 v133, v133, v250
    v_mul_f32 v134, v134, v250
    v_mul_f32 v135, v135, v250
    v_mul_f32 v136, v136, v249
    v_mul_f32 v137, v137, v249
    v_mul_f32 v138, v138, v249
    v_mul_f32 v139, v139, v249
    v_mul_f32 v140, v140, v250
    v_mul_f32 v141, v141, v250
    v_mul_f32 v142, v142, v250
    v_mul_f32 v143, v143, v250
    v_mul_f32 v144, v144, v249
    v_mul_f32 v145, v145, v249
    v_mul_f32 v146, v146, v249
    v_mul_f32 v147, v147, v249
    v_mul_f32 v148, v148, v250
    v_mul_f32 v149, v149, v250
    v_mul_f32 v150, v150, v250
    v_mul_f32 v151, v151, v250
    v_mul_f32 v152, v152, v249
    v_mul_f32 v153, v153, v249
    v_mul_f32 v154, v154, v249
    v_mul_f32 v155, v155, v249
    v_mul_f32 v156, v156, v250
    v_mul_f32 v157, v157, v250
    v_mul_f32 v158, v158, v250
    v_mul_f32 v159, v159, v250
    v_mul_f32 v160, v160, v249
    v_mul_f32 v161, v161, v249
    v_mul_f32 v162, v162, v249
    v_mul_f32 v163, v163, v249
    v_mul_f32 v164, v164, v250
    v_mul_f32 v165, v165, v250
    v_mul_f32 v166, v166, v250
    v_mul_f32 v167, v167, v250
    v_mul_f32 v168, v168, v249
    v_mul_f32 v169, v169, v249
    v_mul_f32 v170, v170, v249
    v_mul_f32 v171, v171, v249
    v_mul_f32 v172, v172, v250
    v_mul_f32 v173, v173, v250
    v_mul_f32 v174, v174, v250
    v_mul_f32 v175, v175, v250
    v_mul_f32 v176, v176, v249
    v_mul_f32 v177, v177, v249
    v_mul_f32 v178, v178, v249
    v_mul_f32 v179, v179, v249
    v_mul_f32 v180, v180, v250
    v_mul_f32 v181, v181, v250
    v_mul_f32 v182, v182, v250
    v_mul_f32 v183, v183, v250
    v_mul_f32 v184, v184, v249
    v_mul_f32 v185, v185, v249
    v_mul_f32 v186, v186, v249
    v_mul_f32 v187, v187, v249
    v_mul_f32 v188, v188, v250
    v_mul_f32 v189, v189, v250
    v_mul_f32 v190, v190, v250
    v_mul_f32 v191, v191, v250
    v_exp_f32 v212, v80
    v_exp_f32 v213, v81
    v_exp_f32 v214, v82
    v_cvt_pk_bf16_f32 v112, v212, v213
    v_exp_f32 v215, v83
    v_exp_f32 v216, v88
    v_cvt_pk_bf16_f32 v113, v214, v215
    v_exp_f32 v217, v89
    v_exp_f32 v218, v90
    v_cvt_pk_bf16_f32 v114, v216, v217
    v_exp_f32 v219, v91
    v_exp_f32 v212, v84
    v_cvt_pk_bf16_f32 v115, v218, v219
    v_exp_f32 v213, v85
    v_exp_f32 v214, v86
    v_cvt_pk_bf16_f32 v116, v212, v213
    v_exp_f32 v215, v87
    v_exp_f32 v216, v92
    v_cvt_pk_bf16_f32 v117, v214, v215
    v_exp_f32 v217, v93
    v_exp_f32 v218, v94
    v_cvt_pk_bf16_f32 v118, v216, v217
    v_exp_f32 v219, v95
    s_nop 0
    v_cvt_pk_bf16_f32 v119, v218, v219
    s_nop 1
    s_branch L_slow_9_ret
L_slow_10:
    s_nop 7
    v_max3_f32 v247, v96, v97, v98
    v_max3_f32 v247, v247, v99, v104
    v_max3_f32 v247, v247, v105, v106
    v_max_f32 v247, v247, v107
    v_max3_f32 v248, v100, v101, v102
    v_max3_f32 v248, v248, v103, v108
    v_max3_f32 v248, v248, v109, v110
    v_max_f32 v248, v248, v111
    v_mov_b32 v249, v247
    v_mov_b32 v250, v248
    s_nop 0
    v_permlane16_swap_b32 v247, v249
    v_permlane16_swap_b32 v248, v250
    s_nop 0
    v_max_f32 v247, v247, v249
    v_max_f32 v248, v248, v250
    v_mov_b32 v249, v247
    v_mov_b32 v250, v248
    s_nop 0
    v_permlane32_swap_b32 v247, v249
    v_permlane32_swap_b32 v248, v250
    s_nop 0
    v_max_f32 v247, v247, v249
    v_max_f32 v248, v248, v250
    v_add_f32 v247, 0x40e00000, v247
    v_add_f32 v248, 0x40e00000, v248
    v_max_f32 v247, 0, v247
    v_max_f32 v248, 0, v248
    v_sub_f32 v249, 0, v247
    v_sub_f32 v250, 0, v248
    v_exp_f32 v249, v249
    v_exp_f32 v250, v250
    v_sub_f32 v96, v96, v247
    v_sub_f32 v97, v97, v247
    v_sub_f32 v98, v98, v247
    v_sub_f32 v99, v99, v247
    v_sub_f32 v104, v104, v247
    v_sub_f32 v105, v105, v247
    v_sub_f32 v106, v106, v247
    v_sub_f32 v107, v107, v247
    v_mul_f32 v200, v200, v249
    v_mul_f32 v201, v201, v249
    v_mul_f32 v202, v202, v249
    v_mul_f32 v203, v203, v249
    v_sub_f32 v100, v100, v248
    v_sub_f32 v101, v101, v248
    v_sub_f32 v102, v102, v248
    v_sub_f32 v103, v103, v248
    v_sub_f32 v108, v108, v248
    v_sub_f32 v109, v109, v248
    v_sub_f32 v110, v110, v248
    v_sub_f32 v111, v111, v248
    v_mul_f32 v204, v204, v250
    v_mul_f32 v205, v205, v250
    v_mul_f32 v206, v206, v250
    v_mul_f32 v207, v207, v250
    v_mul_f32 v128, v128, v249
    v_mul_f32 v129, v129, v249
    v_mul_f32 v130, v130, v249
    v_mul_f32 v131, v131, v249
    v_mul_f32 v132, v132, v250
    v_mul_f32 v133, v133, v250
    v_mul_f32 v134, v134, v250
    v_mul_f32 v135, v135, v250
    v_mul_f32 v136, v136, v249
    v_mul_f32 v137, v137, v249
    v_mul_f32 v138, v138, v249
    v_mul_f32 v139, v139, v249
    v_mul_f32 v140, v140, v250
    v_mul_f32 v141, v141, v250
    v_mul_f32 v142, v142, v250
    v_mul_f32 v143, v143, v250
    v_mul_f32 v144, v144, v249
    v_mul_f32 v145, v145, v249
    v_mul_f32 v146, v146, v249
    v_mul_f32 v147, v147, v249
    v_mul_f32 v148, v148, v250
    v_mul_f32 v149, v149, v250
    v_mul_f32 v150, v150, v250
    v_mul_f32 v151, v151, v250
    v_mul_f32 v152, v152, v249
    v_mul_f32 v153, v153, v249
    v_mul_f32 v154, v154, v249
    v_mul_f32 v155, v155, v249
    v_mul_f32 v156, v156, v250
    v_mul_f32 v157, v157, v250
    v_mul_f32 v158, v158, v250
    v_mul_f32 v159, v159, v250
    v_mul_f32 v160, v160, v249
    v_mul_f32 v161, v161, v249
    v_mul_f32 v162, v162, v249
    v_mul_f32 v163, v163, v249
    v_mul_f32 v164, v164, v250
    v_mul_f32 v165, v165, v250
    v_mul_f32 v166, v166, v250
    v_mul_f32 v167, v167, v250
    v_mul_f32 v168, v168, v249
    v_mul_f32 v169, v169, v249
    v_mul_f32 v170, v170, v249
    v_mul_f32 v171, v171, v249
    v_mul_f32 v172, v172, v250
    v_mul_f32 v173, v173, v250
    v_mul_f32 v174, v174, v250
    v_mul_f32 v175, v175, v250
    v_mul_f32 v176, v176, v249
    v_mul_f32 v177, v177, v249
    v_mul_f32 v178, v178, v249
    v_mul_f32 v179, v179, v249
    v_mul_f32 v180, v180, v250
    v_mul_f32 v181, v181, v250
    v_mul_f32 v182, v182, v250
    v_mul_f32 v183, v183, v250
    v_mul_f32 v184, v184, v249
    v_mul_f32 v185, v185, v249
    v_mul_f32 v186, v186, v249
    v_mul_f32 v187, v187, v249
    v_mul_f32 v188, v188, v250
    v_mul_f32 v189, v189, v250
    v_mul_f32 v190, v190, v250
    v_mul_f32 v191, v191, v250
    v_exp_f32 v212, v96
    v_exp_f32 v213, v97
    v_exp_f32 v214, v98
    v_cvt_pk_bf16_f32 v120, v212, v213
    v_exp_f32 v215, v99
    v_exp_f32 v216, v104
    v_cvt_pk_bf16_f32 v121, v214, v215
    v_exp_f32 v217, v105
    v_exp_f32 v218, v106
    v_cvt_pk_bf16_f32 v122, v216, v217
    v_exp_f32 v219, v107
    v_exp_f32 v212, v100
    v_cvt_pk_bf16_f32 v123, v218, v219
    v_exp_f32 v213, v101
    v_exp_f32 v214, v102
    v_cvt_pk_bf16_f32 v124, v212, v213
    v_exp_f32 v215, v103
    v_exp_f32 v216, v108
    v_cvt_pk_bf16_f32 v125, v214, v215
    v_exp_f32 v217, v109
    v_exp_f32 v218, v110
    v_cvt_pk_bf16_f32 v126, v216, v217
    v_exp_f32 v219, v111
    s_nop 0
    v_cvt_pk_bf16_f32 v127, v218, v219
    s_nop 1
    s_branch L_slow_10_ret
L_slow_11:
    s_nop 7
    v_max3_f32 v247, v96, v97, v98
    v_max3_f32 v247, v247, v99, v104
    v_max3_f32 v247, v247, v105, v106
    v_max_f32 v247, v247, v107
    v_max3_f32 v248, v100, v101, v102
    v_max3_f32 v248, v248, v103, v108
    v_max3_f32 v248, v248, v109, v110
    v_max_f32 v248, v248, v111
    v_mov_b32 v249, v247
    v_mov_b32 v250, v248
    s_nop 0
    v_permlane16_swap_b32 v247, v249
    v_permlane16_swap_b32 v248, v250
    s_nop 0
    v_max_f32 v247, v247, v249
    v_max_f32 v248, v248, v250
    v_mov_b32 v249, v247
    v_mov_b32 v250, v248
    s_nop 0
    v_permlane32_swap_b32 v247, v249
    v_permlane32_swap_b32 v248, v250
    s_nop 0
    v_max_f32 v247, v247, v249
    v_max_f32 v248, v248, v250
    v_add_f32 v247, 0x40e00000, v247
    v_add_f32 v248, 0x40e00000, v248
    v_max_f32 v247, 0, v247
    v_max_f32 v248, 0, v248
    v_sub_f32 v249, 0, v247
    v_sub_f32 v250, 0, v248
    v_exp_f32 v249, v249
    v_exp_f32 v250, v250
    v_sub_f32 v96, v96, v247
    v_sub_f32 v97, v97, v247
    v_sub_f32 v98, v98, v247
    v_sub_f32 v99, v99, v247
    v_sub_f32 v104, v104, v247
    v_sub_f32 v105, v105, v247
    v_sub_f32 v106, v106, v247
    v_sub_f32 v107, v107, v247
    v_mul_f32 v200, v200, v249
    v_mul_f32 v201, v201, v249
    v_mul_f32 v202, v202, v249
    v_mul_f32 v203, v203, v249
    v_sub_f32 v100, v100, v248
    v_sub_f32 v101, v101, v248
    v_sub_f32 v102, v102, v248
    v_sub_f32 v103, v103, v248
    v_sub_f32 v108, v108, v248
    v_sub_f32 v109, v109, v248
    v_sub_f32 v110, v110, v248
    v_sub_f32 v111, v111, v248
    v_mul_f32 v204, v204, v250
    v_mul_f32 v205, v205, v250
    v_mul_f32 v206, v206, v250
    v_mul_f32 v207, v207, v250
    v_mul_f32 v128, v128, v249
    v_mul_f32 v129, v129, v249
    v_mul_f32 v130, v130, v249
    v_mul_f32 v131, v131, v249
    v_mul_f32 v132, v132, v250
    v_mul_f32 v133, v133, v250
    v_mul_f32 v134, v134, v250
    v_mul_f32 v135, v135, v250
    v_mul_f32 v136, v136, v249
    v_mul_f32 v137, v137, v249
    v_mul_f32 v138, v138, v249
    v_mul_f32 v139, v139, v249
    v_mul_f32 v140, v140, v250
    v_mul_f32 v141, v141, v250
    v_mul_f32 v142, v142, v250
    v_mul_f32 v143, v143, v250
    v_mul_f32 v144, v144, v249
    v_mul_f32 v145, v145, v249
    v_mul_f32 v146, v146, v249
    v_mul_f32 v147, v147, v249
    v_mul_f32 v148, v148, v250
    v_mul_f32 v149, v149, v250
    v_mul_f32 v150, v150, v250
    v_mul_f32 v151, v151, v250
    v_mul_f32 v152, v152, v249
    v_mul_f32 v153, v153, v249
    v_mul_f32 v154, v154, v249
    v_mul_f32 v155, v155, v249
    v_mul_f32 v156, v156, v250
    v_mul_f32 v157, v157, v250
    v_mul_f32 v158, v158, v250
    v_mul_f32 v159, v159, v250
    v_mul_f32 v160, v160, v249
    v_mul_f32 v161, v161, v249
    v_mul_f32 v162, v162, v249
    v_mul_f32 v163, v163, v249
    v_mul_f32 v164, v164, v250
    v_mul_f32 v165, v165, v250
    v_mul_f32 v166, v166, v250
    v_mul_f32 v167, v167, v250
    v_mul_f32 v168, v168, v249
    v_mul_f32 v169, v169, v249
    v_mul_f32 v170, v170, v249
    v_mul_f32 v171, v171, v249
    v_mul_f32 v172, v172, v250
    v_mul_f32 v173, v173, v250
    v_mul_f32 v174, v174, v250
    v_mul_f32 v175, v175, v250
    v_mul_f32 v176, v176, v249
    v_mul_f32 v177, v177, v249
    v_mul_f32 v178, v178, v249
    v_mul_f32 v179, v179, v249
    v_mul_f32 v180, v180, v250
    v_mul_f32 v181, v181, v250
    v_mul_f32 v182, v182, v250
    v_mul_f32 v183, v183, v250
    v_mul_f32 v184, v184, v249
    v_mul_f32 v185, v185, v249
    v_mul_f32 v186, v186, v249
    v_mul_f32 v187, v187, v249
    v_mul_f32 v188, v188, v250
    v_mul_f32 v189, v189, v250
    v_mul_f32 v190, v190, v250
    v_mul_f32 v191, v191, v250
    v_exp_f32 v212, v96
    v_exp_f32 v213, v97
    v_exp_f32 v214, v98
    v_cvt_pk_bf16_f32 v120, v212, v213
    v_exp_f32 v215, v99
    v_exp_f32 v216, v104
    v_cvt_pk_bf16_f32 v121, v214, v215
    v_exp_f32 v217, v105
    v_exp_f32 v218, v106
    v_cvt_pk_bf16_f32 v122, v216, v217
    v_exp_f32 v219, v107
    v_exp_f32 v212, v100
    v_cvt_pk_bf16_f32 v123, v218, v219
    v_exp_f32 v213, v101
    v_exp_f32 v214, v102
    v_cvt_pk_bf16_f32 v124, v212, v213
    v_exp_f32 v215, v103
    v_exp_f32 v216, v108
    v_cvt_pk_bf16_f32 v125, v214, v215
    v_exp_f32 v217, v109
    v_exp_f32 v218, v110
    v_cvt_pk_bf16_f32 v126, v216, v217
    v_exp_f32 v219, v111
    s_nop 0
    v_cvt_pk_bf16_f32 v127, v218, v219
    s_nop 1
    s_branch L_slow_11_ret
.section .rodata,"a"
.p2align 6
.amdhsa_kernel concat_heads__mha_block_cached__gqa_block_cached__near_ridge_kernel
  .amdhsa_next_free_vgpr 256
  .amdhsa_next_free_sgpr 102
  .amdhsa_accum_offset 256
  .amdhsa_group_segment_fixed_size 0
  .amdhsa_kernarg_size 104
  .amdhsa_user_sgpr_count 2
  .amdhsa_user_sgpr_kernarg_segment_ptr 1
  .amdhsa_system_sgpr_workgroup_id_x 1
  .amdhsa_float_denorm_mode_32 3
.end_amdhsa_kernel
```
